```python
import torch

def _softmax(x, axis=-1):
    return torch.softmax(x, dim=axis)
def _gelu(x):
    return torch.nn.functional.gelu(x, approximate="tanh")
def _silu(x):
    return torch.nn.functional.silu(x)
def _sigmoid(x):
    return torch.sigmoid(x)
def _layernorm(x, axis=-1, eps=1e-5):
    m = x.mean(dim=axis, keepdim=True)
    v = x.var(dim=axis, keepdim=True, unbiased=False)
    return (x - m) / torch.sqrt(v + eps)
def _scatter_add(tgt, idx, src, axis=0):
    return tgt.clone().index_add_(axis, idx, src)
def _segment_sum(src, seg, n):
    out = torch.zeros((n,) + src.shape[1:], dtype=src.dtype)
    return out.index_add_(0, seg, src)
def _pad(x, pw):
    flat = tuple(v for pair in reversed(pw) for v in pair)
    return torch.nn.functional.pad(x, flat)

kernel_name = 'standalone__mha_block_cached__decode'

def setup_inputs():

    _w = (lambda a: (lambda t: t.to(torch.bfloat16) if t.is_floating_point() else t)(torch.as_tensor(a)))
    B, Sq, D = 4, 1, 512
    H, Sk, Dh = 32, 4096, 128
    return {
        "x": _w((lambda *s: torch.randn(*s, dtype=torch.bfloat16) * 0.8)(B, Sq, D)),
        "k_cache": _w((lambda *s: torch.randn(*s, dtype=torch.bfloat16) * 0.8)(B, H, Sk, Dh)),
        "v_cache": _w((lambda *s: torch.randn(*s, dtype=torch.bfloat16) * 0.05)(B, H, Sk, Dh)),
        "wq": _w((lambda *s: torch.randn(*s, dtype=torch.bfloat16) * 0.8)(D, H * Dh) * (D ** -0.5)),
        "wo": _w((lambda *s: torch.randn(*s, dtype=torch.bfloat16) * 0.05)(H * Dh, D) * ((H * Dh) ** -0.5)),
    }

def reference(x, k_cache, v_cache, wq, wo):
    B, Sq, D = x.shape
    H, Dh = 32, 128
    q = (lambda x, *d: x.permute(*d))((x @ wq).reshape(B, Sq, H, Dh), 0, 2, 1, 3)
    scores = torch.einsum("bhqd,bhkd->bhqk", q, k_cache) * (Dh ** -0.5)
    p = _softmax(scores, axis=-1)
    o = torch.einsum("bhqk,bhkd->bhqd", p, v_cache)
    return (lambda x, *d: x.permute(*d))(o, 0, 2, 1, 3).reshape(B, Sq, H * Dh) @ wo
```

```asm
; @launch grid=(256,1,1) block=(512,1,1) lds=146432
.amdgcn_target "amdgcn-amd-amdhsa--gfx950"
.text
.globl standalone__mha_block_cached__decode_kernel
.p2align 8
.type standalone__mha_block_cached__decode_kernel,@function
standalone__mha_block_cached__decode_kernel:
    s_cmp_ge_u32 s2, 256
    s_cbranch_scc1 L_end
    s_load_dwordx16 s[4:19], s[0:1], 0
    v_lshrrev_b32 v16, 6, v0
    v_and_b32 v0, 63, v0
    v_readfirstlane_b32 s44, v16
    s_and_b32 s45, s2, 7
    s_lshr_b32 s48, s2, 3
    s_lshr_b32 s49, s48, 3
    s_and_b32 s48, s48, 7
    s_lshr_b32 s46, s48, 1
    s_and_b32 s47, s48, 1
    s_lshl_b32 s54, s46, 3
    s_add_u32 s54, s54, s45
    s_lshl_b32 s54, s54, 2
    s_add_u32 s54, s54, s49
    s_lshl_b32 s54, s54, 1
    s_add_u32 s54, s54, s47
    s_lshl_b32 s48, s49, 2
    s_lshr_b32 s48, 0x6530, s48
    s_and_b32 s48, s48, 7
    s_xor_b32 s45, s45, s48
    s_lshl_b32 s45, s45, 2
    s_add_u32 s45, s45, s49
    s_and_b32 s53, s44, 3
    v_lshrrev_b32 v1, 4, v0
    v_and_b32 v2, 15, v0
    v_mov_b32 v3, 0
    s_cmp_ge_u32 s44, 4
    s_cbranch_scc1 L_helper
    s_lshl_b32 s48, s44, 10
    v_lshlrev_b32 v4, 4, v0
    v_add_u32 v4, s48, v4
    v_add_u32 v5, 3072, v4
    v_add_u32 v6, 6144, v4
    v_add_u32 v9, 9216, v4
    s_lshl_b32 s48, s46, 5
    s_add_u32 s48, s48, s45
    s_lshl_b32 s48, s48, 20
    s_lshl_b32 s49, s47, 15
    s_add_u32 s48, s48, s49
    s_mov_b32 s22, 0xf8000
    s_mov_b32 s23, 0x20000
    s_mov_b32 s52, 0
    s_mul_i32 s49, s44, 32768
    s_add_u32 s49, s49, 15360
    s_waitcnt lgkmcnt(0)
    s_add_u32 s20, s6, s48
    s_addc_u32 s21, s7, 0
    s_add_u32 s24, s8, s48
    s_addc_u32 s25, s9, 0
    s_mov_b32 m0, s49
    s_add_u32 s49, s49, 0x1000
    buffer_load_dwordx4 v4, s[20:23], s52 offen offset:0 nt lds
    buffer_load_dwordx4 v5, s[20:23], s52 offen offset:1024 nt lds
    buffer_load_dwordx4 v6, s[20:23], s52 offen offset:2048 nt lds
    buffer_load_dwordx4 v9, s[20:23], s52 offen offset:3072 nt lds
    s_add_u32 s52, s52, 0x4000
    s_mov_b32 m0, s49
    s_add_u32 s49, s49, 0x1000
    buffer_load_dwordx4 v4, s[20:23], s52 offen offset:0 nt lds
    buffer_load_dwordx4 v5, s[20:23], s52 offen offset:1024 nt lds
    s_mov_b32 s50, 0x3e0293ee
    s_mov_b32 s86, 0x00010001
    s_mov_b32 s87, 0x00010001
    v_mov_b32 v15, 1
    v_lshlrev_b32 v7, 5, v2
    v_lshl_add_u32 v7, v1, 3, v7
    s_lshl_b32 s48, s53, 9
    v_add_u32 v7, s48, v7
    v_lshlrev_b32 v8, 3, v0
    s_lshl_b32 s48, s53, 11
    s_add_u32 s48, s48, 7168
    v_lshlrev_b32 v12, 4, v1
    v_add_u32 v12, s48, v12
    s_lshl_b32 s48, s53, 2
    v_mov_b32 v13, s48
    v_mov_b32 v11, 0xff800000
    s_mov_b32 s40, s18
    s_mov_b32 s41, s19
    s_mov_b32 s42, 0x800000
    s_mov_b32 s43, 0x20000
    s_lshr_b32 s48, s2, 5
    s_lshl_b32 s48, s48, 3
    s_and_b32 s85, s2, 7
    s_add_u32 s48, s48, s85
    s_lshr_b32 s84, s48, 4
    s_and_b32 s85, s48, 15
    s_and_b32 s88, s2, 24
    v_lshlrev_b32 v10, 4, v2
    v_add_u32 v12, 512, v12
    s_mov_b64 vcc, 0
    s_mov_b32 s51, 0
    v_mov_b32 v24, 0
    v_mov_b32 v25, 0
    v_mov_b32 v26, 0
    v_mov_b32 v27, 0
    v_mov_b32 v28, 0
    v_mov_b32 v29, 0
    v_mov_b32 v30, 0
    v_mov_b32 v31, 0
    s_barrier
    s_waitcnt vmcnt(5)
    buffer_load_dwordx4 v6, s[20:23], s52 offen offset:2048 nt lds
    s_waitcnt vmcnt(5)
    buffer_load_dwordx4 v9, s[20:23], s52 offen offset:3072 nt lds
    s_add_u32 s52, s52, 0xc000
    s_mov_b32 m0, s49
    s_add_u32 s49, s49, 0x1000
    s_waitcnt vmcnt(5)
    buffer_load_dwordx4 v4, s[20:23], s52 offen offset:0 nt lds
    s_waitcnt vmcnt(5)
    buffer_load_dwordx4 v5, s[20:23], s52 offen offset:1024 nt lds
    s_waitcnt vmcnt(5)
    buffer_load_dwordx4 v6, s[20:23], s52 offen offset:2048 nt lds
    s_waitcnt vmcnt(5)
    buffer_load_dwordx4 v9, s[20:23], s52 offen offset:3072 nt lds
    s_add_u32 s52, s52, 0x4000
    s_mov_b32 m0, s49
    s_add_u32 s49, s49, 0x1000
    s_waitcnt vmcnt(5)
    buffer_load_dwordx4 v4, s[20:23], s52 offen offset:0 nt lds
    s_waitcnt vmcnt(5)
    buffer_load_dwordx4 v5, s[20:23], s52 offen offset:1024 nt lds
    s_waitcnt vmcnt(5)
    buffer_load_dwordx4 v6, s[20:23], s52 offen offset:2048 nt lds
    s_waitcnt vmcnt(5)
    buffer_load_dwordx4 v9, s[20:23], s52 offen offset:3072 nt lds
    s_add_u32 s52, s52, 0xc000
    s_mov_b32 m0, s49
    s_add_u32 s49, s49, 0x1000
    s_waitcnt vmcnt(5)
    buffer_load_dwordx4 v4, s[20:23], s52 offen offset:0 nt lds
    s_waitcnt vmcnt(5)
    buffer_load_dwordx4 v5, s[20:23], s52 offen offset:1024 nt lds
    s_waitcnt vmcnt(5)
    buffer_load_dwordx4 v6, s[20:23], s52 offen offset:2048 nt lds
    s_waitcnt vmcnt(5)
    buffer_load_dwordx4 v9, s[20:23], s52 offen offset:3072 nt lds
    s_add_u32 s52, s52, 0x4000
    s_mov_b32 m0, s49
    s_add_u32 s49, s49, 0x1000
    s_waitcnt vmcnt(5)
    buffer_load_dwordx4 v4, s[20:23], s52 offen offset:0 nt lds
    s_waitcnt vmcnt(5)
    buffer_load_dwordx4 v5, s[20:23], s52 offen offset:1024 nt lds
    s_waitcnt vmcnt(5)
    buffer_load_dwordx4 v6, s[20:23], s52 offen offset:2048 nt lds
    s_waitcnt vmcnt(5)
    buffer_load_dwordx4 v9, s[20:23], s52 offen offset:3072 nt lds
    s_add_u32 s52, s52, 0xc000
    s_mov_b32 m0, s49
    s_add_u32 s49, s49, 0x1000
    s_waitcnt vmcnt(5)
    buffer_load_dwordx4 v4, s[20:23], s52 offen offset:0 nt lds
    s_waitcnt vmcnt(5)
    buffer_load_dwordx4 v5, s[20:23], s52 offen offset:1024 nt lds
    s_waitcnt vmcnt(5)
    buffer_load_dwordx4 v6, s[20:23], s52 offen offset:2048 nt lds
    s_waitcnt vmcnt(5)
    buffer_load_dwordx4 v9, s[20:23], s52 offen offset:3072 nt lds
    s_add_u32 s52, s52, 0x4000
    s_mov_b32 m0, s49
    s_add_u32 s49, s49, 0x1000
    s_waitcnt vmcnt(5)
    buffer_load_dwordx4 v4, s[20:23], s52 offen offset:0 nt lds
    s_waitcnt vmcnt(5)
    buffer_load_dwordx4 v5, s[20:23], s52 offen offset:1024 nt lds
    s_waitcnt vmcnt(5)
    buffer_load_dwordx4 v6, s[20:23], s52 offen offset:2048 nt lds
    s_waitcnt vmcnt(5)
    buffer_load_dwordx4 v9, s[20:23], s52 offen offset:3072 nt lds
    s_add_u32 s52, s52, 0xc000
    s_waitcnt vmcnt(5)
    buffer_load_dwordx4 v[80:83], v4, s[20:23], s52 offen offset:0 nt
    s_waitcnt vmcnt(5)
    buffer_load_dwordx4 v[84:87], v5, s[20:23], s52 offen offset:1024 nt
    s_waitcnt vmcnt(5)
    buffer_load_dwordx4 v[88:91], v6, s[20:23], s52 offen offset:2048 nt
    s_waitcnt vmcnt(5)
    buffer_load_dwordx4 v[92:95], v9, s[20:23], s52 offen offset:3072 nt
    s_add_u32 s52, s52, 0x4000
    s_waitcnt vmcnt(5)
    buffer_load_dwordx4 v[96:99], v4, s[20:23], s52 offen offset:0 nt
    s_waitcnt vmcnt(5)
    buffer_load_dwordx4 v[100:103], v5, s[20:23], s52 offen offset:1024 nt
    ds_write_b32 v13, v15 offset:6688
    s_waitcnt vmcnt(5)
    buffer_load_dwordx4 v[104:107], v6, s[20:23], s52 offen offset:2048 nt
    s_waitcnt vmcnt(5)
    buffer_load_dwordx4 v[108:111], v9, s[20:23], s52 offen offset:3072 nt
    s_add_u32 s52, s52, 0xc000
    s_waitcnt vmcnt(5)
    buffer_load_dwordx4 v[112:115], v4, s[20:23], s52 offen offset:0 nt
    s_waitcnt vmcnt(5)
    buffer_load_dwordx4 v[116:119], v5, s[20:23], s52 offen offset:1024 nt
    s_waitcnt vmcnt(5)
    buffer_load_dwordx4 v[120:123], v6, s[20:23], s52 offen offset:2048 nt
    s_waitcnt vmcnt(5)
    buffer_load_dwordx4 v[124:127], v9, s[20:23], s52 offen offset:3072 nt
    s_add_u32 s52, s52, 0x4000
    s_waitcnt vmcnt(5)
    buffer_load_dwordx4 v[128:131], v4, s[20:23], s52 offen offset:0 nt
    s_waitcnt vmcnt(5)
    buffer_load_dwordx4 v[132:135], v5, s[20:23], s52 offen offset:1024 nt
    s_waitcnt vmcnt(5)
    buffer_load_dwordx4 v[136:139], v6, s[20:23], s52 offen offset:2048 nt
    s_waitcnt vmcnt(5)
    buffer_load_dwordx4 v[140:143], v9, s[20:23], s52 offen offset:3072 nt
    s_add_u32 s52, s52, 0xc000
L_qspin:
    ds_read_b32 v16, v3 offset:6664
    ds_read_b128 v[20:23], v10 offset:6144
    s_waitcnt lgkmcnt(0)
    v_readfirstlane_b32 s48, v16
    s_nop 1
    s_cmp_eq_u32 s48, 0
    s_nop 0
    s_cbranch_scc1 L_qspin
    s_branch L_k4
L_kloop:
    s_cmp_lg_u32 s51, 4
    s_cbranch_scc1 L_ksame
    s_mov_b32 s20, s24
    s_mov_b32 s21, s25
    s_mov_b32 s52, 0
L_ksame:
    s_waitcnt vmcnt(4)
    buffer_load_dwordx4 v[80:83], v4, s[20:23], s52 offen offset:0 nt
    v_dot2_f32_bf16 v32, v112, v20, 0
    v_dot2_f32_bf16 v33, v116, v20, 0
    v_dot2_f32_bf16 v34, v120, v20, 0
    v_dot2_f32_bf16 v35, v124, v20, 0
    v_dot2c_f32_bf16 v32, v113, v21
    v_dot2c_f32_bf16 v33, v117, v21
    v_dot2c_f32_bf16 v34, v121, v21
    v_dot2c_f32_bf16 v35, v125, v21
    s_waitcnt vmcnt(4)
    buffer_load_dwordx4 v[84:87], v5, s[20:23], s52 offen offset:1024 nt
    v_dot2c_f32_bf16 v32, v114, v22
    v_dot2c_f32_bf16 v33, v118, v22
    v_dot2c_f32_bf16 v34, v122, v22
    v_dot2c_f32_bf16 v35, v126, v22
    v_dot2c_f32_bf16 v32, v115, v23
    v_dot2c_f32_bf16 v33, v119, v23
    v_dot2c_f32_bf16 v34, v123, v23
    v_dot2c_f32_bf16 v35, v127, v23
    s_waitcnt vmcnt(4)
    buffer_load_dwordx4 v[88:91], v6, s[20:23], s52 offen offset:2048 nt
    v_add_f32_dpp v32, v32, v32 row_ror:8 row_mask:0xf bank_mask:0xf
    v_add_f32_dpp v33, v33, v33 row_ror:8 row_mask:0xf bank_mask:0xf
    v_add_f32_dpp v34, v34, v34 row_ror:8 row_mask:0xf bank_mask:0xf
    v_add_f32_dpp v35, v35, v35 row_ror:8 row_mask:0xf bank_mask:0xf
    v_add_f32_dpp v32, v32, v32 row_ror:4 row_mask:0xf bank_mask:0xf
    v_add_f32_dpp v33, v33, v33 row_ror:4 row_mask:0xf bank_mask:0xf
    v_add_f32_dpp v34, v34, v34 row_ror:4 row_mask:0xf bank_mask:0xf
    v_add_f32_dpp v35, v35, v35 row_ror:4 row_mask:0xf bank_mask:0xf
    s_waitcnt vmcnt(4)
    buffer_load_dwordx4 v[92:95], v9, s[20:23], s52 offen offset:3072 nt
    v_add_f32_dpp v32, v32, v32 row_ror:2 row_mask:0xf bank_mask:0xf
    v_add_f32_dpp v33, v33, v33 row_ror:2 row_mask:0xf bank_mask:0xf
    v_add_f32_dpp v34, v34, v34 row_ror:2 row_mask:0xf bank_mask:0xf
    v_add_f32_dpp v35, v35, v35 row_ror:2 row_mask:0xf bank_mask:0xf
    v_add_f32_dpp v32, v32, v32 row_ror:1 row_mask:0xf bank_mask:0xf
    v_add_f32_dpp v33, v33, v33 row_ror:1 row_mask:0xf bank_mask:0xf
    v_add_f32_dpp v34, v34, v34 row_ror:1 row_mask:0xf bank_mask:0xf
    v_add_f32_dpp v35, v35, v35 row_ror:1 row_mask:0xf bank_mask:0xf
    s_mov_b64 exec, s[86:87]
    ds_write_b128 v12, v[32:35] offset:128
    s_mov_b64 exec, -1
    v_max3_f32 v11, v11, v32, v33
    v_max3_f32 v11, v11, v34, v35
    s_add_u32 s52, s52, 0x4000
    s_waitcnt vmcnt(4)
    buffer_load_dwordx4 v[96:99], v4, s[20:23], s52 offen offset:0 nt
    v_dot2_f32_bf16 v32, v128, v20, 0
    v_dot2_f32_bf16 v33, v132, v20, 0
    v_dot2_f32_bf16 v34, v136, v20, 0
    v_dot2_f32_bf16 v35, v140, v20, 0
    v_dot2c_f32_bf16 v32, v129, v21
    v_dot2c_f32_bf16 v33, v133, v21
    v_dot2c_f32_bf16 v34, v137, v21
    v_dot2c_f32_bf16 v35, v141, v21
    s_waitcnt vmcnt(4)
    buffer_load_dwordx4 v[100:103], v5, s[20:23], s52 offen offset:1024 nt
    v_dot2c_f32_bf16 v32, v130, v22
    v_dot2c_f32_bf16 v33, v134, v22
    v_dot2c_f32_bf16 v34, v138, v22
    v_dot2c_f32_bf16 v35, v142, v22
    v_dot2c_f32_bf16 v32, v131, v23
    v_dot2c_f32_bf16 v33, v135, v23
    v_dot2c_f32_bf16 v34, v139, v23
    v_dot2c_f32_bf16 v35, v143, v23
    s_waitcnt vmcnt(4)
    buffer_load_dwordx4 v[104:107], v6, s[20:23], s52 offen offset:2048 nt
    v_add_f32_dpp v32, v32, v32 row_ror:8 row_mask:0xf bank_mask:0xf
    v_add_f32_dpp v33, v33, v33 row_ror:8 row_mask:0xf bank_mask:0xf
    v_add_f32_dpp v34, v34, v34 row_ror:8 row_mask:0xf bank_mask:0xf
    v_add_f32_dpp v35, v35, v35 row_ror:8 row_mask:0xf bank_mask:0xf
    v_add_f32_dpp v32, v32, v32 row_ror:4 row_mask:0xf bank_mask:0xf
    v_add_f32_dpp v33, v33, v33 row_ror:4 row_mask:0xf bank_mask:0xf
    v_add_f32_dpp v34, v34, v34 row_ror:4 row_mask:0xf bank_mask:0xf
    v_add_f32_dpp v35, v35, v35 row_ror:4 row_mask:0xf bank_mask:0xf
    s_waitcnt vmcnt(4)
    buffer_load_dwordx4 v[108:111], v9, s[20:23], s52 offen offset:3072 nt
    v_add_f32_dpp v32, v32, v32 row_ror:2 row_mask:0xf bank_mask:0xf
    v_add_f32_dpp v33, v33, v33 row_ror:2 row_mask:0xf bank_mask:0xf
    v_add_f32_dpp v34, v34, v34 row_ror:2 row_mask:0xf bank_mask:0xf
    v_add_f32_dpp v35, v35, v35 row_ror:2 row_mask:0xf bank_mask:0xf
    v_add_f32_dpp v32, v32, v32 row_ror:1 row_mask:0xf bank_mask:0xf
    v_add_f32_dpp v33, v33, v33 row_ror:1 row_mask:0xf bank_mask:0xf
    v_add_f32_dpp v34, v34, v34 row_ror:1 row_mask:0xf bank_mask:0xf
    v_add_f32_dpp v35, v35, v35 row_ror:1 row_mask:0xf bank_mask:0xf
    s_mov_b64 exec, s[86:87]
    ds_write_b128 v12, v[32:35] offset:192
    s_mov_b64 exec, -1
    v_max3_f32 v11, v11, v32, v33
    v_max3_f32 v11, v11, v34, v35
    s_add_u32 s52, s52, 0xc000
    s_waitcnt vmcnt(4)
    buffer_load_dwordx4 v[112:115], v4, s[20:23], s52 offen offset:0 nt
    v_dot2_f32_bf16 v32, v144, v20, 0
    v_dot2_f32_bf16 v33, v148, v20, 0
    v_dot2_f32_bf16 v34, v152, v20, 0
    v_dot2_f32_bf16 v35, v156, v20, 0
    v_dot2c_f32_bf16 v32, v145, v21
    v_dot2c_f32_bf16 v33, v149, v21
    v_dot2c_f32_bf16 v34, v153, v21
    v_dot2c_f32_bf16 v35, v157, v21
    s_waitcnt vmcnt(4)
    buffer_load_dwordx4 v[116:119], v5, s[20:23], s52 offen offset:1024 nt
    v_dot2c_f32_bf16 v32, v146, v22
    v_dot2c_f32_bf16 v33, v150, v22
    v_dot2c_f32_bf16 v34, v154, v22
    v_dot2c_f32_bf16 v35, v158, v22
    v_dot2c_f32_bf16 v32, v147, v23
    v_dot2c_f32_bf16 v33, v151, v23
    v_dot2c_f32_bf16 v34, v155, v23
    v_dot2c_f32_bf16 v35, v159, v23
    s_waitcnt vmcnt(4)
    buffer_load_dwordx4 v[120:123], v6, s[20:23], s52 offen offset:2048 nt
    v_add_f32_dpp v32, v32, v32 row_ror:8 row_mask:0xf bank_mask:0xf
    v_add_f32_dpp v33, v33, v33 row_ror:8 row_mask:0xf bank_mask:0xf
    v_add_f32_dpp v34, v34, v34 row_ror:8 row_mask:0xf bank_mask:0xf
    v_add_f32_dpp v35, v35, v35 row_ror:8 row_mask:0xf bank_mask:0xf
    v_add_f32_dpp v32, v32, v32 row_ror:4 row_mask:0xf bank_mask:0xf
    v_add_f32_dpp v33, v33, v33 row_ror:4 row_mask:0xf bank_mask:0xf
    v_add_f32_dpp v34, v34, v34 row_ror:4 row_mask:0xf bank_mask:0xf
    v_add_f32_dpp v35, v35, v35 row_ror:4 row_mask:0xf bank_mask:0xf
    s_waitcnt vmcnt(4)
    buffer_load_dwordx4 v[124:127], v9, s[20:23], s52 offen offset:3072 nt
    v_add_f32_dpp v32, v32, v32 row_ror:2 row_mask:0xf bank_mask:0xf
    v_add_f32_dpp v33, v33, v33 row_ror:2 row_mask:0xf bank_mask:0xf
    v_add_f32_dpp v34, v34, v34 row_ror:2 row_mask:0xf bank_mask:0xf
    v_add_f32_dpp v35, v35, v35 row_ror:2 row_mask:0xf bank_mask:0xf
    v_add_f32_dpp v32, v32, v32 row_ror:1 row_mask:0xf bank_mask:0xf
    v_add_f32_dpp v33, v33, v33 row_ror:1 row_mask:0xf bank_mask:0xf
    v_add_f32_dpp v34, v34, v34 row_ror:1 row_mask:0xf bank_mask:0xf
    v_add_f32_dpp v35, v35, v35 row_ror:1 row_mask:0xf bank_mask:0xf
    s_mov_b64 exec, s[86:87]
    ds_write_b128 v12, v[32:35] offset:256
    s_mov_b64 exec, -1
    v_max3_f32 v11, v11, v32, v33
    v_max3_f32 v11, v11, v34, v35
    s_add_u32 s52, s52, 0x4000
    s_waitcnt vmcnt(4)
    buffer_load_dwordx4 v[128:131], v4, s[20:23], s52 offen offset:0 nt
    v_dot2_f32_bf16 v32, v160, v20, 0
    v_dot2_f32_bf16 v33, v164, v20, 0
    v_dot2_f32_bf16 v34, v168, v20, 0
    v_dot2_f32_bf16 v35, v172, v20, 0
    v_dot2c_f32_bf16 v32, v161, v21
    v_dot2c_f32_bf16 v33, v165, v21
    v_dot2c_f32_bf16 v34, v169, v21
    v_dot2c_f32_bf16 v35, v173, v21
    s_waitcnt vmcnt(4)
    buffer_load_dwordx4 v[132:135], v5, s[20:23], s52 offen offset:1024 nt
    v_dot2c_f32_bf16 v32, v162, v22
    v_dot2c_f32_bf16 v33, v166, v22
    v_dot2c_f32_bf16 v34, v170, v22
    v_dot2c_f32_bf16 v35, v174, v22
    v_dot2c_f32_bf16 v32, v163, v23
    v_dot2c_f32_bf16 v33, v167, v23
    v_dot2c_f32_bf16 v34, v171, v23
    v_dot2c_f32_bf16 v35, v175, v23
    s_waitcnt vmcnt(4)
    buffer_load_dwordx4 v[136:139], v6, s[20:23], s52 offen offset:2048 nt
    v_add_f32_dpp v32, v32, v32 row_ror:8 row_mask:0xf bank_mask:0xf
    v_add_f32_dpp v33, v33, v33 row_ror:8 row_mask:0xf bank_mask:0xf
    v_add_f32_dpp v34, v34, v34 row_ror:8 row_mask:0xf bank_mask:0xf
    v_add_f32_dpp v35, v35, v35 row_ror:8 row_mask:0xf bank_mask:0xf
    v_add_f32_dpp v32, v32, v32 row_ror:4 row_mask:0xf bank_mask:0xf
    v_add_f32_dpp v33, v33, v33 row_ror:4 row_mask:0xf bank_mask:0xf
    v_add_f32_dpp v34, v34, v34 row_ror:4 row_mask:0xf bank_mask:0xf
    v_add_f32_dpp v35, v35, v35 row_ror:4 row_mask:0xf bank_mask:0xf
    s_waitcnt vmcnt(4)
    buffer_load_dwordx4 v[140:143], v9, s[20:23], s52 offen offset:3072 nt
    v_add_f32_dpp v32, v32, v32 row_ror:2 row_mask:0xf bank_mask:0xf
    v_add_f32_dpp v33, v33, v33 row_ror:2 row_mask:0xf bank_mask:0xf
    v_add_f32_dpp v34, v34, v34 row_ror:2 row_mask:0xf bank_mask:0xf
    v_add_f32_dpp v35, v35, v35 row_ror:2 row_mask:0xf bank_mask:0xf
    v_add_f32_dpp v32, v32, v32 row_ror:1 row_mask:0xf bank_mask:0xf
    v_add_f32_dpp v33, v33, v33 row_ror:1 row_mask:0xf bank_mask:0xf
    v_add_f32_dpp v34, v34, v34 row_ror:1 row_mask:0xf bank_mask:0xf
    v_add_f32_dpp v35, v35, v35 row_ror:1 row_mask:0xf bank_mask:0xf
    s_mov_b64 exec, s[86:87]
    ds_write_b128 v12, v[32:35] offset:320
    s_mov_b64 exec, -1
    v_max3_f32 v11, v11, v32, v33
    v_max3_f32 v11, v11, v34, v35
    s_add_u32 s52, s52, 0xc000
    v_add_u32 v12, 384, v12
    s_cmp_eq_u32 s51, 4
    s_cbranch_scc1 L_kdone
L_k4:
    s_waitcnt vmcnt(4)
    buffer_load_dwordx4 v[144:147], v4, s[20:23], s52 offen offset:0 nt
    v_dot2_f32_bf16 v32, v80, v20, 0
    v_dot2_f32_bf16 v33, v84, v20, 0
    v_dot2_f32_bf16 v34, v88, v20, 0
    v_dot2_f32_bf16 v35, v92, v20, 0
    v_dot2c_f32_bf16 v32, v81, v21
    v_dot2c_f32_bf16 v33, v85, v21
    v_dot2c_f32_bf16 v34, v89, v21
    v_dot2c_f32_bf16 v35, v93, v21
    s_waitcnt vmcnt(4)
    buffer_load_dwordx4 v[148:151], v5, s[20:23], s52 offen offset:1024 nt
    v_dot2c_f32_bf16 v32, v82, v22
    v_dot2c_f32_bf16 v33, v86, v22
    v_dot2c_f32_bf16 v34, v90, v22
    v_dot2c_f32_bf16 v35, v94, v22
    v_dot2c_f32_bf16 v32, v83, v23
    v_dot2c_f32_bf16 v33, v87, v23
    v_dot2c_f32_bf16 v34, v91, v23
    v_dot2c_f32_bf16 v35, v95, v23
    s_waitcnt vmcnt(4)
    buffer_load_dwordx4 v[152:155], v6, s[20:23], s52 offen offset:2048 nt
    v_add_f32_dpp v32, v32, v32 row_ror:8 row_mask:0xf bank_mask:0xf
    v_add_f32_dpp v33, v33, v33 row_ror:8 row_mask:0xf bank_mask:0xf
    v_add_f32_dpp v34, v34, v34 row_ror:8 row_mask:0xf bank_mask:0xf
    v_add_f32_dpp v35, v35, v35 row_ror:8 row_mask:0xf bank_mask:0xf
    v_add_f32_dpp v32, v32, v32 row_ror:4 row_mask:0xf bank_mask:0xf
    v_add_f32_dpp v33, v33, v33 row_ror:4 row_mask:0xf bank_mask:0xf
    v_add_f32_dpp v34, v34, v34 row_ror:4 row_mask:0xf bank_mask:0xf
    v_add_f32_dpp v35, v35, v35 row_ror:4 row_mask:0xf bank_mask:0xf
    s_waitcnt vmcnt(4)
    buffer_load_dwordx4 v[156:159], v9, s[20:23], s52 offen offset:3072 nt
    v_add_f32_dpp v32, v32, v32 row_ror:2 row_mask:0xf bank_mask:0xf
    v_add_f32_dpp v33, v33, v33 row_ror:2 row_mask:0xf bank_mask:0xf
    v_add_f32_dpp v34, v34, v34 row_ror:2 row_mask:0xf bank_mask:0xf
    v_add_f32_dpp v35, v35, v35 row_ror:2 row_mask:0xf bank_mask:0xf
    v_add_f32_dpp v32, v32, v32 row_ror:1 row_mask:0xf bank_mask:0xf
    v_add_f32_dpp v33, v33, v33 row_ror:1 row_mask:0xf bank_mask:0xf
    v_add_f32_dpp v34, v34, v34 row_ror:1 row_mask:0xf bank_mask:0xf
    v_add_f32_dpp v35, v35, v35 row_ror:1 row_mask:0xf bank_mask:0xf
    s_mov_b64 exec, s[86:87]
    ds_write_b128 v12, v[32:35] offset:0
    s_mov_b64 exec, -1
    v_max3_f32 v11, v11, v32, v33
    v_max3_f32 v11, v11, v34, v35
    s_add_u32 s52, s52, 0x4000
    s_waitcnt vmcnt(4)
    buffer_load_dwordx4 v[160:163], v4, s[20:23], s52 offen offset:0 nt
    v_dot2_f32_bf16 v32, v96, v20, 0
    v_dot2_f32_bf16 v33, v100, v20, 0
    v_dot2_f32_bf16 v34, v104, v20, 0
    v_dot2_f32_bf16 v35, v108, v20, 0
    v_dot2c_f32_bf16 v32, v97, v21
    v_dot2c_f32_bf16 v33, v101, v21
    v_dot2c_f32_bf16 v34, v105, v21
    v_dot2c_f32_bf16 v35, v109, v21
    s_waitcnt vmcnt(4)
    buffer_load_dwordx4 v[164:167], v5, s[20:23], s52 offen offset:1024 nt
    v_dot2c_f32_bf16 v32, v98, v22
    v_dot2c_f32_bf16 v33, v102, v22
    v_dot2c_f32_bf16 v34, v106, v22
    v_dot2c_f32_bf16 v35, v110, v22
    v_dot2c_f32_bf16 v32, v99, v23
    v_dot2c_f32_bf16 v33, v103, v23
    v_dot2c_f32_bf16 v34, v107, v23
    v_dot2c_f32_bf16 v35, v111, v23
    s_waitcnt vmcnt(4)
    buffer_load_dwordx4 v[168:171], v6, s[20:23], s52 offen offset:2048 nt
    v_add_f32_dpp v32, v32, v32 row_ror:8 row_mask:0xf bank_mask:0xf
    v_add_f32_dpp v33, v33, v33 row_ror:8 row_mask:0xf bank_mask:0xf
    v_add_f32_dpp v34, v34, v34 row_ror:8 row_mask:0xf bank_mask:0xf
    v_add_f32_dpp v35, v35, v35 row_ror:8 row_mask:0xf bank_mask:0xf
    v_add_f32_dpp v32, v32, v32 row_ror:4 row_mask:0xf bank_mask:0xf
    v_add_f32_dpp v33, v33, v33 row_ror:4 row_mask:0xf bank_mask:0xf
    v_add_f32_dpp v34, v34, v34 row_ror:4 row_mask:0xf bank_mask:0xf
    v_add_f32_dpp v35, v35, v35 row_ror:4 row_mask:0xf bank_mask:0xf
    s_waitcnt vmcnt(4)
    buffer_load_dwordx4 v[172:175], v9, s[20:23], s52 offen offset:3072 nt
    v_add_f32_dpp v32, v32, v32 row_ror:2 row_mask:0xf bank_mask:0xf
    v_add_f32_dpp v33, v33, v33 row_ror:2 row_mask:0xf bank_mask:0xf
    v_add_f32_dpp v34, v34, v34 row_ror:2 row_mask:0xf bank_mask:0xf
    v_add_f32_dpp v35, v35, v35 row_ror:2 row_mask:0xf bank_mask:0xf
    v_add_f32_dpp v32, v32, v32 row_ror:1 row_mask:0xf bank_mask:0xf
    v_add_f32_dpp v33, v33, v33 row_ror:1 row_mask:0xf bank_mask:0xf
    v_add_f32_dpp v34, v34, v34 row_ror:1 row_mask:0xf bank_mask:0xf
    v_add_f32_dpp v35, v35, v35 row_ror:1 row_mask:0xf bank_mask:0xf
    s_mov_b64 exec, s[86:87]
    ds_write_b128 v12, v[32:35] offset:64
    s_mov_b64 exec, -1
    v_max3_f32 v11, v11, v32, v33
    v_max3_f32 v11, v11, v34, v35
    s_add_u32 s52, s52, 0xc000
    s_add_u32 s51, s51, 1
    s_branch L_kloop
L_kdone:
    v_subrev_u32 v12, 2048, v12
    v_lshlrev_b32 v17, 2, v1
    v_lshl_add_u32 v17, v13, 2, v17
    s_waitcnt lgkmcnt(0)
    ds_write_b32 v13, v15 offset:6720
L_rspin:
    ds_read_b32 v16, v13 offset:6704
    ds_read_b32 v14, v17 offset:6848
    ds_read_b128 v[32:35], v12
    s_waitcnt lgkmcnt(0)
    v_readfirstlane_b32 s48, v16
    s_nop 1
    s_cmp_eq_u32 s48, 0
    s_nop 0
    s_cbranch_scc1 L_rspin
    v_max_f32 v11, v11, v14
    v_mul_f32 v14, s50, v11
    s_mov_b32 s91, 27
    s_mov_b32 s90, 44
    s_mov_b32 s89, 0
    v_mov_b32 v76, 0
    v_mov_b32 v77, 0
    v_mov_b32 v78, 0
    v_mov_b32 v79, 0
    s_nop 0
    s_branch L_v4
L_vloop:
    s_add_u32 s91, s91, 1
    s_cmp_lt_u32 s91, s90
    s_cbranch_scc0 L_d2_0_0
    s_waitcnt vmcnt(4)
L_d2_0_0:
    s_waitcnt vmcnt(9)
    buffer_load_dwordx4 v[80:83], v4, s[20:23], s52 offen offset:0 nt
    s_waitcnt lgkmcnt(0)
    ds_read_b128 v[36:39], v12 offset:192
    v_fma_f32 v32, v32, s50, -v14
    v_fma_f32 v33, v33, s50, -v14
    v_fma_f32 v34, v34, s50, -v14
    v_fma_f32 v35, v35, s50, -v14
    v_exp_f32 v32, v32
    v_exp_f32 v33, v33
    v_exp_f32 v34, v34
    v_exp_f32 v35, v35
    v_cvt_pk_bf16_f32 v40, v32, 0
    v_cvt_pk_bf16_f32 v41, v33, 0
    v_cvt_pk_bf16_f32 v42, v34, 0
    v_cvt_pk_bf16_f32 v43, v35, 0
    v_lshlrev_b32 v44, 16, v40
    v_lshlrev_b32 v45, 16, v41
    v_lshlrev_b32 v46, 16, v42
    v_lshlrev_b32 v47, 16, v43
    s_cbranch_scc0 L_d2_0_1
    s_waitcnt vmcnt(4)
L_d2_0_1:
    s_waitcnt vmcnt(9)
    buffer_load_dwordx4 v[84:87], v5, s[20:23], s52 offen offset:1024 nt
    v_dot2c_f32_bf16 v24, v112, v40
    v_dot2c_f32_bf16 v25, v112, v44
    v_dot2c_f32_bf16 v26, v113, v40
    v_dot2c_f32_bf16 v27, v113, v44
    v_dot2c_f32_bf16 v28, v114, v40
    v_dot2c_f32_bf16 v29, v114, v44
    v_dot2c_f32_bf16 v30, v115, v40
    v_dot2c_f32_bf16 v31, v115, v44
    v_dot2c_f32_bf16 v24, v116, v41
    v_dot2c_f32_bf16 v25, v116, v45
    v_dot2c_f32_bf16 v26, v117, v41
    v_dot2c_f32_bf16 v27, v117, v45
    s_cbranch_scc0 L_d2_0_2
    s_waitcnt vmcnt(4)
L_d2_0_2:
    s_waitcnt vmcnt(9)
    buffer_load_dwordx4 v[88:91], v6, s[20:23], s52 offen offset:2048 nt
    v_dot2c_f32_bf16 v28, v118, v41
    v_dot2c_f32_bf16 v29, v118, v45
    v_dot2c_f32_bf16 v30, v119, v41
    v_dot2c_f32_bf16 v31, v119, v45
    v_dot2c_f32_bf16 v24, v120, v42
    v_dot2c_f32_bf16 v25, v120, v46
    v_dot2c_f32_bf16 v26, v121, v42
    v_dot2c_f32_bf16 v27, v121, v46
    v_dot2c_f32_bf16 v28, v122, v42
    v_dot2c_f32_bf16 v29, v122, v46
    s_cbranch_scc0 L_d2_0_3
    s_waitcnt vmcnt(4)
L_d2_0_3:
    s_waitcnt vmcnt(9)
    buffer_load_dwordx4 v[92:95], v9, s[20:23], s52 offen offset:3072 nt
    v_dot2c_f32_bf16 v30, v123, v42
    v_dot2c_f32_bf16 v31, v123, v46
    v_dot2c_f32_bf16 v24, v124, v43
    v_dot2c_f32_bf16 v25, v124, v47
    v_dot2c_f32_bf16 v26, v125, v43
    v_dot2c_f32_bf16 v27, v125, v47
    v_dot2c_f32_bf16 v28, v126, v43
    v_dot2c_f32_bf16 v29, v126, v47
    v_dot2c_f32_bf16 v30, v127, v43
    v_dot2c_f32_bf16 v31, v127, v47
    s_add_u32 s52, s52, 0x4000
    s_add_u32 s91, s91, 1
    s_cmp_lt_u32 s91, s90
    s_cbranch_scc0 L_d2_1_0
    s_waitcnt vmcnt(4)
L_d2_1_0:
    s_waitcnt vmcnt(9)
    buffer_load_dwordx4 v[96:99], v4, s[20:23], s52 offen offset:0 nt
    s_waitcnt lgkmcnt(0)
    ds_read_b128 v[32:35], v12 offset:256
    v_fma_f32 v36, v36, s50, -v14
    v_fma_f32 v37, v37, s50, -v14
    v_fma_f32 v38, v38, s50, -v14
    v_fma_f32 v39, v39, s50, -v14
    v_exp_f32 v36, v36
    v_exp_f32 v37, v37
    v_exp_f32 v38, v38
    v_exp_f32 v39, v39
    v_cvt_pk_bf16_f32 v40, v36, 0
    v_cvt_pk_bf16_f32 v41, v37, 0
    v_cvt_pk_bf16_f32 v42, v38, 0
    v_cvt_pk_bf16_f32 v43, v39, 0
    v_lshlrev_b32 v44, 16, v40
    v_lshlrev_b32 v45, 16, v41
    v_lshlrev_b32 v46, 16, v42
    v_lshlrev_b32 v47, 16, v43
    s_cbranch_scc0 L_d2_1_1
    s_waitcnt vmcnt(4)
L_d2_1_1:
    s_waitcnt vmcnt(9)
    buffer_load_dwordx4 v[100:103], v5, s[20:23], s52 offen offset:1024 nt
    v_dot2c_f32_bf16 v24, v128, v40
    v_dot2c_f32_bf16 v25, v128, v44
    v_dot2c_f32_bf16 v26, v129, v40
    v_dot2c_f32_bf16 v27, v129, v44
    v_dot2c_f32_bf16 v28, v130, v40
    v_dot2c_f32_bf16 v29, v130, v44
    v_dot2c_f32_bf16 v30, v131, v40
    v_dot2c_f32_bf16 v31, v131, v44
    v_dot2c_f32_bf16 v24, v132, v41
    v_dot2c_f32_bf16 v25, v132, v45
    v_dot2c_f32_bf16 v26, v133, v41
    v_dot2c_f32_bf16 v27, v133, v45
    s_cbranch_scc0 L_d2_1_2
    s_waitcnt vmcnt(4)
L_d2_1_2:
    s_waitcnt vmcnt(9)
    buffer_load_dwordx4 v[104:107], v6, s[20:23], s52 offen offset:2048 nt
    v_dot2c_f32_bf16 v28, v134, v41
    v_dot2c_f32_bf16 v29, v134, v45
    v_dot2c_f32_bf16 v30, v135, v41
    v_dot2c_f32_bf16 v31, v135, v45
    v_dot2c_f32_bf16 v24, v136, v42
    v_dot2c_f32_bf16 v25, v136, v46
    v_dot2c_f32_bf16 v26, v137, v42
    v_dot2c_f32_bf16 v27, v137, v46
    v_dot2c_f32_bf16 v28, v138, v42
    v_dot2c_f32_bf16 v29, v138, v46
    s_cbranch_scc0 L_d2_1_3
    s_waitcnt vmcnt(4)
L_d2_1_3:
    s_waitcnt vmcnt(9)
    buffer_load_dwordx4 v[108:111], v9, s[20:23], s52 offen offset:3072 nt
    v_dot2c_f32_bf16 v30, v139, v42
    v_dot2c_f32_bf16 v31, v139, v46
    v_dot2c_f32_bf16 v24, v140, v43
    v_dot2c_f32_bf16 v25, v140, v47
    v_dot2c_f32_bf16 v26, v141, v43
    v_dot2c_f32_bf16 v27, v141, v47
    v_dot2c_f32_bf16 v28, v142, v43
    v_dot2c_f32_bf16 v29, v142, v47
    v_dot2c_f32_bf16 v30, v143, v43
    v_dot2c_f32_bf16 v31, v143, v47
    s_add_u32 s52, s52, 0xc000
    s_cmp_eq_u32 s51, 9
    s_cselect_b64 vcc, -1, 0
    s_add_u32 s91, s91, 1
    s_cmp_lt_u32 s91, s90
    s_cbranch_vccnz L_sk2_0
    s_cbranch_scc0 L_d2_2_0
    s_waitcnt vmcnt(4)
L_d2_2_0:
    s_waitcnt vmcnt(9)
    buffer_load_dwordx4 v[112:115], v4, s[20:23], s52 offen offset:0 nt
L_sk2_0:
    s_waitcnt lgkmcnt(0)
    ds_read_b128 v[36:39], v12 offset:320
    v_fma_f32 v32, v32, s50, -v14
    v_fma_f32 v33, v33, s50, -v14
    v_fma_f32 v34, v34, s50, -v14
    v_fma_f32 v35, v35, s50, -v14
    v_exp_f32 v32, v32
    v_exp_f32 v33, v33
    v_exp_f32 v34, v34
    v_exp_f32 v35, v35
    v_cvt_pk_bf16_f32 v40, v32, 0
    v_cvt_pk_bf16_f32 v41, v33, 0
    v_cvt_pk_bf16_f32 v42, v34, 0
    v_cvt_pk_bf16_f32 v43, v35, 0
    v_lshlrev_b32 v44, 16, v40
    v_lshlrev_b32 v45, 16, v41
    v_lshlrev_b32 v46, 16, v42
    v_lshlrev_b32 v47, 16, v43
    s_cbranch_vccnz L_sk2_1
    s_cbranch_scc0 L_d2_2_1
    s_waitcnt vmcnt(4)
L_d2_2_1:
    s_waitcnt vmcnt(9)
    buffer_load_dwordx4 v[116:119], v5, s[20:23], s52 offen offset:1024 nt
L_sk2_1:
    v_dot2c_f32_bf16 v24, v144, v40
    v_dot2c_f32_bf16 v25, v144, v44
    v_dot2c_f32_bf16 v26, v145, v40
    v_dot2c_f32_bf16 v27, v145, v44
    v_dot2c_f32_bf16 v28, v146, v40
    v_dot2c_f32_bf16 v29, v146, v44
    v_dot2c_f32_bf16 v30, v147, v40
    v_dot2c_f32_bf16 v31, v147, v44
    v_dot2c_f32_bf16 v24, v148, v41
    v_dot2c_f32_bf16 v25, v148, v45
    v_dot2c_f32_bf16 v26, v149, v41
    v_dot2c_f32_bf16 v27, v149, v45
    s_cbranch_vccnz L_sk2_2
    s_cbranch_scc0 L_d2_2_2
    s_waitcnt vmcnt(4)
L_d2_2_2:
    s_waitcnt vmcnt(9)
    buffer_load_dwordx4 v[120:123], v6, s[20:23], s52 offen offset:2048 nt
L_sk2_2:
    v_dot2c_f32_bf16 v28, v150, v41
    v_dot2c_f32_bf16 v29, v150, v45
    v_dot2c_f32_bf16 v30, v151, v41
    v_dot2c_f32_bf16 v31, v151, v45
    v_dot2c_f32_bf16 v24, v152, v42
    v_dot2c_f32_bf16 v25, v152, v46
    v_dot2c_f32_bf16 v26, v153, v42
    v_dot2c_f32_bf16 v27, v153, v46
    v_dot2c_f32_bf16 v28, v154, v42
    v_dot2c_f32_bf16 v29, v154, v46
    s_cbranch_vccnz L_sk2_3
    s_cbranch_scc0 L_d2_2_3
    s_waitcnt vmcnt(4)
L_d2_2_3:
    s_waitcnt vmcnt(9)
    buffer_load_dwordx4 v[124:127], v9, s[20:23], s52 offen offset:3072 nt
L_sk2_3:
    v_dot2c_f32_bf16 v30, v155, v42
    v_dot2c_f32_bf16 v31, v155, v46
    v_dot2c_f32_bf16 v24, v156, v43
    v_dot2c_f32_bf16 v25, v156, v47
    v_dot2c_f32_bf16 v26, v157, v43
    v_dot2c_f32_bf16 v27, v157, v47
    v_dot2c_f32_bf16 v28, v158, v43
    v_dot2c_f32_bf16 v29, v158, v47
    v_dot2c_f32_bf16 v30, v159, v43
    v_dot2c_f32_bf16 v31, v159, v47
    s_add_u32 s52, s52, 0x4000
    s_add_u32 s91, s91, 1
    s_cmp_lt_u32 s91, s90
    s_cbranch_vccnz L_sk3_0
    s_cbranch_scc0 L_d2_3_0
    s_waitcnt vmcnt(4)
L_d2_3_0:
    s_waitcnt vmcnt(9)
    buffer_load_dwordx4 v[128:131], v4, s[20:23], s52 offen offset:0 nt
L_sk3_0:
    s_waitcnt lgkmcnt(0)
    ds_read_b128 v[32:35], v12 offset:384
    v_fma_f32 v36, v36, s50, -v14
    v_fma_f32 v37, v37, s50, -v14
    v_fma_f32 v38, v38, s50, -v14
    v_fma_f32 v39, v39, s50, -v14
    v_exp_f32 v36, v36
    v_exp_f32 v37, v37
    v_exp_f32 v38, v38
    v_exp_f32 v39, v39
    v_cvt_pk_bf16_f32 v40, v36, 0
    v_cvt_pk_bf16_f32 v41, v37, 0
    v_cvt_pk_bf16_f32 v42, v38, 0
    v_cvt_pk_bf16_f32 v43, v39, 0
    v_lshlrev_b32 v44, 16, v40
    v_lshlrev_b32 v45, 16, v41
    v_lshlrev_b32 v46, 16, v42
    v_lshlrev_b32 v47, 16, v43
    s_cbranch_vccnz L_sk3_1
    s_cbranch_scc0 L_d2_3_1
    s_waitcnt vmcnt(4)
L_d2_3_1:
    s_waitcnt vmcnt(9)
    buffer_load_dwordx4 v[132:135], v5, s[20:23], s52 offen offset:1024 nt
L_sk3_1:
    s_cbranch_vccz L_dw3_0
    s_waitcnt vmcnt(11)
L_dw3_0:
    v_dot2c_f32_bf16 v24, v160, v40
    v_dot2c_f32_bf16 v25, v160, v44
    v_dot2c_f32_bf16 v26, v161, v40
    v_dot2c_f32_bf16 v27, v161, v44
    v_dot2c_f32_bf16 v28, v162, v40
    v_dot2c_f32_bf16 v29, v162, v44
    v_dot2c_f32_bf16 v30, v163, v40
    v_dot2c_f32_bf16 v31, v163, v44
    s_cbranch_vccz L_dw3_1
    s_waitcnt vmcnt(10)
L_dw3_1:
    v_dot2c_f32_bf16 v24, v164, v41
    v_dot2c_f32_bf16 v25, v164, v45
    v_dot2c_f32_bf16 v26, v165, v41
    v_dot2c_f32_bf16 v27, v165, v45
    v_dot2c_f32_bf16 v28, v166, v41
    v_dot2c_f32_bf16 v29, v166, v45
    v_dot2c_f32_bf16 v30, v167, v41
    v_dot2c_f32_bf16 v31, v167, v45
    s_cbranch_vccnz L_sk3_2
    s_cbranch_scc0 L_d2_3_2
    s_waitcnt vmcnt(4)
L_d2_3_2:
    s_waitcnt vmcnt(9)
    buffer_load_dwordx4 v[136:139], v6, s[20:23], s52 offen offset:2048 nt
L_sk3_2:
    s_cbranch_vccz L_dw3_2
    s_waitcnt vmcnt(9)
L_dw3_2:
    v_dot2c_f32_bf16 v24, v168, v42
    v_dot2c_f32_bf16 v25, v168, v46
    v_dot2c_f32_bf16 v26, v169, v42
    v_dot2c_f32_bf16 v27, v169, v46
    v_dot2c_f32_bf16 v28, v170, v42
    v_dot2c_f32_bf16 v29, v170, v46
    v_dot2c_f32_bf16 v30, v171, v42
    v_dot2c_f32_bf16 v31, v171, v46
    s_cbranch_vccnz L_sk3_3
    s_cbranch_scc0 L_d2_3_3
    s_waitcnt vmcnt(4)
L_d2_3_3:
    s_waitcnt vmcnt(9)
    buffer_load_dwordx4 v[140:143], v9, s[20:23], s52 offen offset:3072 nt
L_sk3_3:
    s_cbranch_vccz L_dw3_3
    s_waitcnt vmcnt(8)
L_dw3_3:
    v_dot2c_f32_bf16 v24, v172, v43
    v_dot2c_f32_bf16 v25, v172, v47
    v_dot2c_f32_bf16 v26, v173, v43
    v_dot2c_f32_bf16 v27, v173, v47
    v_dot2c_f32_bf16 v28, v174, v43
    v_dot2c_f32_bf16 v29, v174, v47
    v_dot2c_f32_bf16 v30, v175, v43
    v_dot2c_f32_bf16 v31, v175, v47
    s_add_u32 s52, s52, 0xc000
    v_add_u32 v12, 384, v12
    s_nop 1
L_v4:
    s_add_u32 s91, s91, 1
    s_cmp_lt_u32 s91, s90
    s_cbranch_vccnz L_sk4_0
    s_cbranch_scc0 L_d2_4_0
    s_waitcnt vmcnt(4)
L_d2_4_0:
    s_waitcnt vmcnt(9)
    buffer_load_dwordx4 v[144:147], v4, s[20:23], s52 offen offset:0 nt
L_sk4_0:
    s_waitcnt lgkmcnt(0)
    ds_read_b128 v[36:39], v12 offset:64
    v_fma_f32 v32, v32, s50, -v14
    v_fma_f32 v33, v33, s50, -v14
    v_fma_f32 v34, v34, s50, -v14
    v_fma_f32 v35, v35, s50, -v14
    v_exp_f32 v32, v32
    v_exp_f32 v33, v33
    v_exp_f32 v34, v34
    v_exp_f32 v35, v35
    v_cvt_pk_bf16_f32 v40, v32, 0
    v_cvt_pk_bf16_f32 v41, v33, 0
    v_cvt_pk_bf16_f32 v42, v34, 0
    v_cvt_pk_bf16_f32 v43, v35, 0
    v_lshlrev_b32 v44, 16, v40
    v_lshlrev_b32 v45, 16, v41
    v_lshlrev_b32 v46, 16, v42
    v_lshlrev_b32 v47, 16, v43
    s_cbranch_vccnz L_sk4_1
    s_cbranch_scc0 L_d2_4_1
    s_waitcnt vmcnt(4)
L_d2_4_1:
    s_waitcnt vmcnt(9)
    buffer_load_dwordx4 v[148:151], v5, s[20:23], s52 offen offset:1024 nt
L_sk4_1:
    s_cbranch_vccz L_dw4_0
    s_waitcnt vmcnt(7)
L_dw4_0:
    v_dot2c_f32_bf16 v24, v80, v40
    v_dot2c_f32_bf16 v25, v80, v44
    v_dot2c_f32_bf16 v26, v81, v40
    v_dot2c_f32_bf16 v27, v81, v44
    v_dot2c_f32_bf16 v28, v82, v40
    v_dot2c_f32_bf16 v29, v82, v44
    v_dot2c_f32_bf16 v30, v83, v40
    v_dot2c_f32_bf16 v31, v83, v44
    s_cbranch_vccz L_dw4_1
    s_waitcnt vmcnt(6)
L_dw4_1:
    v_dot2c_f32_bf16 v24, v84, v41
    v_dot2c_f32_bf16 v25, v84, v45
    v_dot2c_f32_bf16 v26, v85, v41
    v_dot2c_f32_bf16 v27, v85, v45
    v_dot2c_f32_bf16 v28, v86, v41
    v_dot2c_f32_bf16 v29, v86, v45
    v_dot2c_f32_bf16 v30, v87, v41
    v_dot2c_f32_bf16 v31, v87, v45
    s_cbranch_vccnz L_sk4_2
    s_cbranch_scc0 L_d2_4_2
    s_waitcnt vmcnt(4)
L_d2_4_2:
    s_waitcnt vmcnt(9)
    buffer_load_dwordx4 v[152:155], v6, s[20:23], s52 offen offset:2048 nt
L_sk4_2:
    s_cbranch_vccz L_dw4_2
    s_waitcnt vmcnt(5)
L_dw4_2:
    v_dot2c_f32_bf16 v24, v88, v42
    v_dot2c_f32_bf16 v25, v88, v46
    v_dot2c_f32_bf16 v26, v89, v42
    v_dot2c_f32_bf16 v27, v89, v46
    v_dot2c_f32_bf16 v28, v90, v42
    v_dot2c_f32_bf16 v29, v90, v46
    v_dot2c_f32_bf16 v30, v91, v42
    v_dot2c_f32_bf16 v31, v91, v46
    s_cbranch_vccnz L_sk4_3
    s_cbranch_scc0 L_d2_4_3
    s_waitcnt vmcnt(4)
L_d2_4_3:
    s_waitcnt vmcnt(9)
    buffer_load_dwordx4 v[156:159], v9, s[20:23], s52 offen offset:3072 nt
L_sk4_3:
    s_cbranch_vccz L_dw4_3
    s_waitcnt vmcnt(4)
L_dw4_3:
    v_dot2c_f32_bf16 v24, v92, v43
    v_dot2c_f32_bf16 v25, v92, v47
    v_dot2c_f32_bf16 v26, v93, v43
    v_dot2c_f32_bf16 v27, v93, v47
    v_dot2c_f32_bf16 v28, v94, v43
    v_dot2c_f32_bf16 v29, v94, v47
    v_dot2c_f32_bf16 v30, v95, v43
    v_dot2c_f32_bf16 v31, v95, v47
    s_add_u32 s52, s52, 0x4000
    s_cmp_lg_u32 s51, 9
    s_cbranch_scc1 L_nosc
L_mspin:
    ds_read_b64 v[16:17], v3 offset:6672
    s_waitcnt lgkmcnt(0)
    v_readfirstlane_b32 s48, v16
    s_nop 1
    s_cmp_eq_u32 s48, 0
    s_nop 0
    s_cbranch_scc1 L_mspin
    v_sub_f32 v11, v14, v17
    v_exp_f32 v11, v11
    v_mov_b32 v14, v17
    v_mul_f32 v24, v24, v11
    v_mul_f32 v25, v25, v11
    v_mul_f32 v26, v26, v11
    v_mul_f32 v27, v27, v11
    v_mul_f32 v28, v28, v11
    v_mul_f32 v29, v29, v11
    v_mul_f32 v30, v30, v11
    v_mul_f32 v31, v31, v11
    s_nop 1
L_nosc:
    s_add_u32 s91, s91, 1
    s_cmp_lt_u32 s91, s90
    s_cbranch_vccnz L_sk5_0
    s_cbranch_scc0 L_d2_5_0
    s_waitcnt vmcnt(4)
L_d2_5_0:
    s_waitcnt vmcnt(9)
    buffer_load_dwordx4 v[160:163], v4, s[20:23], s52 offen offset:0 nt
L_sk5_0:
    s_waitcnt lgkmcnt(0)
    ds_read_b128 v[32:35], v12 offset:128
    v_fma_f32 v36, v36, s50, -v14
    v_fma_f32 v37, v37, s50, -v14
    v_fma_f32 v38, v38, s50, -v14
    v_fma_f32 v39, v39, s50, -v14
    v_exp_f32 v36, v36
    v_exp_f32 v37, v37
    v_exp_f32 v38, v38
    v_exp_f32 v39, v39
    v_cvt_pk_bf16_f32 v40, v36, 0
    v_cvt_pk_bf16_f32 v41, v37, 0
    v_cvt_pk_bf16_f32 v42, v38, 0
    v_cvt_pk_bf16_f32 v43, v39, 0
    v_lshlrev_b32 v44, 16, v40
    v_lshlrev_b32 v45, 16, v41
    v_lshlrev_b32 v46, 16, v42
    v_lshlrev_b32 v47, 16, v43
    s_cbranch_vccnz L_sk5_1
    s_cbranch_scc0 L_d2_5_1
    s_waitcnt vmcnt(4)
L_d2_5_1:
    s_waitcnt vmcnt(9)
    buffer_load_dwordx4 v[164:167], v5, s[20:23], s52 offen offset:1024 nt
L_sk5_1:
    s_cbranch_vccz L_dw5_0
    s_waitcnt vmcnt(3)
L_dw5_0:
    v_dot2c_f32_bf16 v24, v96, v40
    v_dot2c_f32_bf16 v25, v96, v44
    v_dot2c_f32_bf16 v26, v97, v40
    v_dot2c_f32_bf16 v27, v97, v44
    v_dot2c_f32_bf16 v28, v98, v40
    v_dot2c_f32_bf16 v29, v98, v44
    v_dot2c_f32_bf16 v30, v99, v40
    v_dot2c_f32_bf16 v31, v99, v44
    s_cbranch_vccz L_dw5_1
    s_waitcnt vmcnt(2)
L_dw5_1:
    v_dot2c_f32_bf16 v24, v100, v41
    v_dot2c_f32_bf16 v25, v100, v45
    v_dot2c_f32_bf16 v26, v101, v41
    v_dot2c_f32_bf16 v27, v101, v45
    v_dot2c_f32_bf16 v28, v102, v41
    v_dot2c_f32_bf16 v29, v102, v45
    v_dot2c_f32_bf16 v30, v103, v41
    v_dot2c_f32_bf16 v31, v103, v45
    s_cbranch_vccnz L_sk5_2
    s_cbranch_scc0 L_d2_5_2
    s_waitcnt vmcnt(4)
L_d2_5_2:
    s_waitcnt vmcnt(9)
    buffer_load_dwordx4 v[168:171], v6, s[20:23], s52 offen offset:2048 nt
L_sk5_2:
    s_cbranch_vccz L_dw5_2
    s_waitcnt vmcnt(1)
L_dw5_2:
    v_dot2c_f32_bf16 v24, v104, v42
    v_dot2c_f32_bf16 v25, v104, v46
    v_dot2c_f32_bf16 v26, v105, v42
    v_dot2c_f32_bf16 v27, v105, v46
    v_dot2c_f32_bf16 v28, v106, v42
    v_dot2c_f32_bf16 v29, v106, v46
    v_dot2c_f32_bf16 v30, v107, v42
    v_dot2c_f32_bf16 v31, v107, v46
    s_cbranch_vccnz L_sk5_3
    s_cbranch_scc0 L_d2_5_3
    s_waitcnt vmcnt(4)
L_d2_5_3:
    s_waitcnt vmcnt(9)
    buffer_load_dwordx4 v[172:175], v9, s[20:23], s52 offen offset:3072 nt
L_sk5_3:
    s_cbranch_vccz L_dw5_3
    s_waitcnt vmcnt(0)
L_dw5_3:
    v_dot2c_f32_bf16 v24, v108, v43
    v_dot2c_f32_bf16 v25, v108, v47
    v_dot2c_f32_bf16 v26, v109, v43
    v_dot2c_f32_bf16 v27, v109, v47
    v_dot2c_f32_bf16 v28, v110, v43
    v_dot2c_f32_bf16 v29, v110, v47
    v_dot2c_f32_bf16 v30, v111, v43
    v_dot2c_f32_bf16 v31, v111, v47
    s_add_u32 s52, s52, 0xc000
    s_cmp_eq_u32 s51, 9
    s_cbranch_scc1 L_sdone
    s_add_u32 s51, s51, 1
    s_branch L_vloop
L_sdone:
    v_permlane32_swap_b32 v24, v28
    v_permlane32_swap_b32 v25, v29
    v_permlane32_swap_b32 v26, v30
    v_permlane32_swap_b32 v27, v31
    v_add_f32 v24, v24, v28
    v_add_f32 v25, v25, v29
    v_add_f32 v26, v26, v30
    v_add_f32 v27, v27, v31
    s_nop 0
    v_permlane16_swap_b32 v24, v26
    v_permlane16_swap_b32 v25, v27
    v_add_f32 v24, v24, v26
    v_add_f32 v25, v25, v27
    ds_write_b64 v7, v[24:25] offset:2048
    s_waitcnt lgkmcnt(0)
    s_barrier
    s_branch L_cons
L_helper:
    s_lshl_b32 s48, s53, 8
    v_lshlrev_b32 v4, 6, v1
    v_add_u32 v4, s48, v4
    v_lshlrev_b32 v5, 12, v4
    v_lshl_add_u32 v5, v2, 4, v5
    s_mov_b32 s38, 1024
    s_mov_b32 s39, 0x20000
    s_mov_b32 s31, 0x20000
    s_mov_b32 s52, 0
    s_waitcnt lgkmcnt(0)
    s_lshl_b32 s49, s46, 10
    s_add_u32 s36, s4, s49
    s_addc_u32 s37, s5, 0
    s_lshl_b32 s49, s45, 8
    s_add_u32 s28, s10, s49
    s_addc_u32 s29, s11, 0
    s_sub_u32 s30, 4194304, s49
    s_lshr_b32 s51, s2, 4
    s_add_u32 s48, s51, 0
    s_and_b32 s48, s48, 3
    s_lshl_b32 s48, s48, 4
    buffer_load_dwordx4 v[48:51], v4, s[36:39], s48 offen
    s_add_u32 s48, s51, 1
    s_and_b32 s48, s48, 3
    s_lshl_b32 s48, s48, 4
    buffer_load_dwordx4 v[52:55], v4, s[36:39], s48 offen
    s_add_u32 s48, s51, 2
    s_and_b32 s48, s48, 3
    s_lshl_b32 s48, s48, 4
    buffer_load_dwordx4 v[56:59], v4, s[36:39], s48 offen
    s_add_u32 s48, s51, 3
    s_and_b32 s48, s48, 3
    s_lshl_b32 s48, s48, 4
    buffer_load_dwordx4 v[60:63], v4, s[36:39], s48 offen
    s_add_u32 s52, s51, 0
    s_and_b32 s52, s52, 3
    s_lshl_b32 s52, s52, 16
    buffer_load_dwordx4 v[80:83], v5, s[28:31], s52 offen
    s_add_u32 s52, s52, 0x2000
    buffer_load_dwordx4 v[84:87], v5, s[28:31], s52 offen
    s_add_u32 s52, s52, 0x2000
    buffer_load_dwordx4 v[88:91], v5, s[28:31], s52 offen
    s_add_u32 s52, s52, 0x2000
    buffer_load_dwordx4 v[92:95], v5, s[28:31], s52 offen
    s_add_u32 s52, s52, 0x2000
    v_lshlrev_b32 v16, 2, v0
    s_mov_b32 exec_hi, 0
    ds_write_b32 v16, v3 offset:6656
    s_mov_b64 exec, -1
    s_waitcnt lgkmcnt(0)
    s_barrier
    buffer_load_dwordx4 v[96:99], v5, s[28:31], s52 offen
    s_add_u32 s52, s52, 0x2000
    buffer_load_dwordx4 v[100:103], v5, s[28:31], s52 offen
    s_add_u32 s52, s52, 0x2000
    buffer_load_dwordx4 v[104:107], v5, s[28:31], s52 offen
    s_add_u32 s52, s52, 0x2000
    buffer_load_dwordx4 v[108:111], v5, s[28:31], s52 offen
    s_add_u32 s52, s52, 0x2000
    s_add_u32 s52, s51, 1
    s_and_b32 s52, s52, 3
    s_lshl_b32 s52, s52, 16
    buffer_load_dwordx4 v[112:115], v5, s[28:31], s52 offen
    s_add_u32 s52, s52, 0x2000
    buffer_load_dwordx4 v[116:119], v5, s[28:31], s52 offen
    s_add_u32 s52, s52, 0x2000
    buffer_load_dwordx4 v[120:123], v5, s[28:31], s52 offen
    s_add_u32 s52, s52, 0x2000
    buffer_load_dwordx4 v[124:127], v5, s[28:31], s52 offen
    s_add_u32 s52, s52, 0x2000
    buffer_load_dwordx4 v[128:131], v5, s[28:31], s52 offen
    s_add_u32 s52, s52, 0x2000
    buffer_load_dwordx4 v[132:135], v5, s[28:31], s52 offen
    s_add_u32 s52, s52, 0x2000
    buffer_load_dwordx4 v[136:139], v5, s[28:31], s52 offen
    s_add_u32 s52, s52, 0x2000
    buffer_load_dwordx4 v[140:143], v5, s[28:31], s52 offen
    s_add_u32 s52, s52, 0x2000
    s_add_u32 s52, s51, 2
    s_and_b32 s52, s52, 3
    s_lshl_b32 s52, s52, 16
    buffer_load_dwordx4 v[144:147], v5, s[28:31], s52 offen
    s_add_u32 s52, s52, 0x2000
    buffer_load_dwordx4 v[148:151], v5, s[28:31], s52 offen
    s_add_u32 s52, s52, 0x2000
    buffer_load_dwordx4 v[152:155], v5, s[28:31], s52 offen
    s_add_u32 s52, s52, 0x2000
    buffer_load_dwordx4 v[156:159], v5, s[28:31], s52 offen
    s_add_u32 s52, s52, 0x2000
    buffer_load_dwordx4 v[160:163], v5, s[28:31], s52 offen
    s_add_u32 s52, s52, 0x2000
    buffer_load_dwordx4 v[164:167], v5, s[28:31], s52 offen
    s_add_u32 s52, s52, 0x2000
    buffer_load_dwordx4 v[168:171], v5, s[28:31], s52 offen
    s_add_u32 s52, s52, 0x2000
    buffer_load_dwordx4 v[172:175], v5, s[28:31], s52 offen
    s_add_u32 s52, s52, 0x2000
    s_add_u32 s52, s51, 3
    s_and_b32 s52, s52, 3
    s_lshl_b32 s52, s52, 16
    buffer_load_dwordx4 v[176:179], v5, s[28:31], s52 offen
    s_add_u32 s52, s52, 0x2000
    buffer_load_dwordx4 v[180:183], v5, s[28:31], s52 offen
    s_add_u32 s52, s52, 0x2000
    buffer_load_dwordx4 v[184:187], v5, s[28:31], s52 offen
    s_add_u32 s52, s52, 0x2000
    buffer_load_dwordx4 v[188:191], v5, s[28:31], s52 offen
    s_add_u32 s52, s52, 0x2000
    buffer_load_dwordx4 v[192:195], v5, s[28:31], s52 offen
    s_add_u32 s52, s52, 0x2000
    buffer_load_dwordx4 v[196:199], v5, s[28:31], s52 offen
    s_add_u32 s52, s52, 0x2000
    buffer_load_dwordx4 v[200:203], v5, s[28:31], s52 offen
    s_add_u32 s52, s52, 0x2000
    buffer_load_dwordx4 v[204:207], v5, s[28:31], s52 offen
    s_mov_b32 s50, 0x3e0293ee
    s_mov_b32 s86, 0x00010001
    s_mov_b32 s87, 0x00010001
    v_mov_b32 v15, 1
    v_lshlrev_b32 v7, 5, v2
    v_lshl_add_u32 v7, v1, 3, v7
    s_lshl_b32 s48, s53, 9
    v_add_u32 v7, s48, v7
    v_lshlrev_b32 v8, 3, v0
    s_lshl_b32 s48, s53, 11
    s_add_u32 s48, s48, 7168
    v_lshlrev_b32 v12, 4, v1
    v_add_u32 v12, s48, v12
    s_lshl_b32 s48, s53, 2
    v_mov_b32 v13, s48
    v_mov_b32 v11, 0xff800000
    s_mov_b32 s40, s18
    s_mov_b32 s41, s19
    s_mov_b32 s42, 0x800000
    s_mov_b32 s43, 0x20000
    s_lshr_b32 s48, s2, 5
    s_lshl_b32 s48, s48, 3
    s_and_b32 s85, s2, 7
    s_add_u32 s48, s48, s85
    s_lshr_b32 s84, s48, 4
    s_and_b32 s85, s48, 15
    s_and_b32 s88, s2, 24
    v_lshlrev_b32 v6, 5, v2
    v_lshrrev_b32 v16, 5, v0
    v_lshl_add_u32 v6, v16, 4, v6
    s_lshl_b32 s55, s54, 11
    s_lshl_b32 s49, s53, 9
    s_add_u32 s55, s55, s49
    s_lshl_b32 s48, s53, 8
    s_add_u32 s48, s48, 4096
    v_lshlrev_b32 v9, 2, v0
    v_add_u32 v9, s48, v9
    v_lshlrev_b32 v10, 6, v1
    v_add_u32 v10, s48, v10
    s_lshl_b32 s49, s45, 17
    s_add_u32 s32, s12, s49
    s_addc_u32 s33, s13, 0
    s_mov_b32 s34, 131072
    s_mov_b32 s35, 0x20000
    s_mov_b32 s56, s16
    s_mov_b32 s57, s17
    s_mov_b32 s58, 256
    s_mov_b32 s59, 0x20000
    s_waitcnt vmcnt(28)
    v_and_b32 v72, 0xffff, v48
    v_lshlrev_b32 v73, 16, v48
    v_dot2_f32_bf16 v64, v80, v72, 0
    v_dot2_f32_bf16 v65, v80, v73, 0
    v_dot2_f32_bf16 v66, v81, v72, 0
    v_dot2_f32_bf16 v67, v81, v73, 0
    v_dot2_f32_bf16 v68, v82, v72, 0
    v_dot2_f32_bf16 v69, v82, v73, 0
    v_dot2_f32_bf16 v70, v83, v72, 0
    v_dot2_f32_bf16 v71, v83, v73, 0
    v_lshrrev_b32 v74, 16, v48
    v_and_b32 v75, 0xffff0000, v48
    v_dot2c_f32_bf16 v64, v84, v74
    v_dot2c_f32_bf16 v65, v84, v75
    v_dot2c_f32_bf16 v66, v85, v74
    v_dot2c_f32_bf16 v67, v85, v75
    v_dot2c_f32_bf16 v68, v86, v74
    v_dot2c_f32_bf16 v69, v86, v75
    v_dot2c_f32_bf16 v70, v87, v74
    v_dot2c_f32_bf16 v71, v87, v75
    v_and_b32 v72, 0xffff, v49
    v_lshlrev_b32 v73, 16, v49
    v_dot2c_f32_bf16 v64, v88, v72
    v_dot2c_f32_bf16 v65, v88, v73
    v_dot2c_f32_bf16 v66, v89, v72
    v_dot2c_f32_bf16 v67, v89, v73
    v_dot2c_f32_bf16 v68, v90, v72
    v_dot2c_f32_bf16 v69, v90, v73
    v_dot2c_f32_bf16 v70, v91, v72
    v_dot2c_f32_bf16 v71, v91, v73
    v_lshrrev_b32 v74, 16, v49
    v_and_b32 v75, 0xffff0000, v49
    v_dot2c_f32_bf16 v64, v92, v74
    v_dot2c_f32_bf16 v65, v92, v75
    v_dot2c_f32_bf16 v66, v93, v74
    v_dot2c_f32_bf16 v67, v93, v75
    v_dot2c_f32_bf16 v68, v94, v74
    v_dot2c_f32_bf16 v69, v94, v75
    v_dot2c_f32_bf16 v70, v95, v74
    v_dot2c_f32_bf16 v71, v95, v75
    s_waitcnt vmcnt(24)
    v_and_b32 v72, 0xffff, v50
    v_lshlrev_b32 v73, 16, v50
    v_dot2c_f32_bf16 v64, v96, v72
    v_dot2c_f32_bf16 v65, v96, v73
    v_dot2c_f32_bf16 v66, v97, v72
    v_dot2c_f32_bf16 v67, v97, v73
    v_dot2c_f32_bf16 v68, v98, v72
    v_dot2c_f32_bf16 v69, v98, v73
    v_dot2c_f32_bf16 v70, v99, v72
    v_dot2c_f32_bf16 v71, v99, v73
    v_lshrrev_b32 v74, 16, v50
    v_and_b32 v75, 0xffff0000, v50
    v_dot2c_f32_bf16 v64, v100, v74
    v_dot2c_f32_bf16 v65, v100, v75
    v_dot2c_f32_bf16 v66, v101, v74
    v_dot2c_f32_bf16 v67, v101, v75
    v_dot2c_f32_bf16 v68, v102, v74
    v_dot2c_f32_bf16 v69, v102, v75
    v_dot2c_f32_bf16 v70, v103, v74
    v_dot2c_f32_bf16 v71, v103, v75
    v_and_b32 v72, 0xffff, v51
    v_lshlrev_b32 v73, 16, v51
    v_dot2c_f32_bf16 v64, v104, v72
    v_dot2c_f32_bf16 v65, v104, v73
    v_dot2c_f32_bf16 v66, v105, v72
    v_dot2c_f32_bf16 v67, v105, v73
    v_dot2c_f32_bf16 v68, v106, v72
    v_dot2c_f32_bf16 v69, v106, v73
    v_dot2c_f32_bf16 v70, v107, v72
    v_dot2c_f32_bf16 v71, v107, v73
    v_lshrrev_b32 v74, 16, v51
    v_and_b32 v75, 0xffff0000, v51
    v_dot2c_f32_bf16 v64, v108, v74
    v_dot2c_f32_bf16 v65, v108, v75
    v_dot2c_f32_bf16 v66, v109, v74
    v_dot2c_f32_bf16 v67, v109, v75
    v_dot2c_f32_bf16 v68, v110, v74
    v_dot2c_f32_bf16 v69, v110, v75
    v_dot2c_f32_bf16 v70, v111, v74
    v_dot2c_f32_bf16 v71, v111, v75
    s_waitcnt vmcnt(20)
    v_and_b32 v72, 0xffff, v52
    v_lshlrev_b32 v73, 16, v52
    v_dot2c_f32_bf16 v64, v112, v72
    v_dot2c_f32_bf16 v65, v112, v73
    v_dot2c_f32_bf16 v66, v113, v72
    v_dot2c_f32_bf16 v67, v113, v73
    v_dot2c_f32_bf16 v68, v114, v72
    v_dot2c_f32_bf16 v69, v114, v73
    v_dot2c_f32_bf16 v70, v115, v72
    v_dot2c_f32_bf16 v71, v115, v73
    v_lshrrev_b32 v74, 16, v52
    v_and_b32 v75, 0xffff0000, v52
    v_dot2c_f32_bf16 v64, v116, v74
    v_dot2c_f32_bf16 v65, v116, v75
    v_dot2c_f32_bf16 v66, v117, v74
    v_dot2c_f32_bf16 v67, v117, v75
    v_dot2c_f32_bf16 v68, v118, v74
    v_dot2c_f32_bf16 v69, v118, v75
    v_dot2c_f32_bf16 v70, v119, v74
    v_dot2c_f32_bf16 v71, v119, v75
    v_and_b32 v72, 0xffff, v53
    v_lshlrev_b32 v73, 16, v53
    v_dot2c_f32_bf16 v64, v120, v72
    v_dot2c_f32_bf16 v65, v120, v73
    v_dot2c_f32_bf16 v66, v121, v72
    v_dot2c_f32_bf16 v67, v121, v73
    v_dot2c_f32_bf16 v68, v122, v72
    v_dot2c_f32_bf16 v69, v122, v73
    v_dot2c_f32_bf16 v70, v123, v72
    v_dot2c_f32_bf16 v71, v123, v73
    v_lshrrev_b32 v74, 16, v53
    v_and_b32 v75, 0xffff0000, v53
    v_dot2c_f32_bf16 v64, v124, v74
    v_dot2c_f32_bf16 v65, v124, v75
    v_dot2c_f32_bf16 v66, v125, v74
    v_dot2c_f32_bf16 v67, v125, v75
    v_dot2c_f32_bf16 v68, v126, v74
    v_dot2c_f32_bf16 v69, v126, v75
    v_dot2c_f32_bf16 v70, v127, v74
    v_dot2c_f32_bf16 v71, v127, v75
    s_waitcnt vmcnt(16)
    v_and_b32 v72, 0xffff, v54
    v_lshlrev_b32 v73, 16, v54
    v_dot2c_f32_bf16 v64, v128, v72
    v_dot2c_f32_bf16 v65, v128, v73
    v_dot2c_f32_bf16 v66, v129, v72
    v_dot2c_f32_bf16 v67, v129, v73
    v_dot2c_f32_bf16 v68, v130, v72
    v_dot2c_f32_bf16 v69, v130, v73
    v_dot2c_f32_bf16 v70, v131, v72
    v_dot2c_f32_bf16 v71, v131, v73
    v_lshrrev_b32 v74, 16, v54
    v_and_b32 v75, 0xffff0000, v54
    v_dot2c_f32_bf16 v64, v132, v74
    v_dot2c_f32_bf16 v65, v132, v75
    v_dot2c_f32_bf16 v66, v133, v74
    v_dot2c_f32_bf16 v67, v133, v75
    v_dot2c_f32_bf16 v68, v134, v74
    v_dot2c_f32_bf16 v69, v134, v75
    v_dot2c_f32_bf16 v70, v135, v74
    v_dot2c_f32_bf16 v71, v135, v75
    v_and_b32 v72, 0xffff, v55
    v_lshlrev_b32 v73, 16, v55
    v_dot2c_f32_bf16 v64, v136, v72
    v_dot2c_f32_bf16 v65, v136, v73
    v_dot2c_f32_bf16 v66, v137, v72
    v_dot2c_f32_bf16 v67, v137, v73
    v_dot2c_f32_bf16 v68, v138, v72
    v_dot2c_f32_bf16 v69, v138, v73
    v_dot2c_f32_bf16 v70, v139, v72
    v_dot2c_f32_bf16 v71, v139, v73
    v_lshrrev_b32 v74, 16, v55
    v_and_b32 v75, 0xffff0000, v55
    v_dot2c_f32_bf16 v64, v140, v74
    v_dot2c_f32_bf16 v65, v140, v75
    v_dot2c_f32_bf16 v66, v141, v74
    v_dot2c_f32_bf16 v67, v141, v75
    v_dot2c_f32_bf16 v68, v142, v74
    v_dot2c_f32_bf16 v69, v142, v75
    v_dot2c_f32_bf16 v70, v143, v74
    v_dot2c_f32_bf16 v71, v143, v75
    s_waitcnt vmcnt(12)
    v_and_b32 v72, 0xffff, v56
    v_lshlrev_b32 v73, 16, v56
    v_dot2c_f32_bf16 v64, v144, v72
    v_dot2c_f32_bf16 v65, v144, v73
    v_dot2c_f32_bf16 v66, v145, v72
    v_dot2c_f32_bf16 v67, v145, v73
    v_dot2c_f32_bf16 v68, v146, v72
    v_dot2c_f32_bf16 v69, v146, v73
    v_dot2c_f32_bf16 v70, v147, v72
    v_dot2c_f32_bf16 v71, v147, v73
    v_lshrrev_b32 v74, 16, v56
    v_and_b32 v75, 0xffff0000, v56
    v_dot2c_f32_bf16 v64, v148, v74
    v_dot2c_f32_bf16 v65, v148, v75
    v_dot2c_f32_bf16 v66, v149, v74
    v_dot2c_f32_bf16 v67, v149, v75
    v_dot2c_f32_bf16 v68, v150, v74
    v_dot2c_f32_bf16 v69, v150, v75
    v_dot2c_f32_bf16 v70, v151, v74
    v_dot2c_f32_bf16 v71, v151, v75
    v_and_b32 v72, 0xffff, v57
    v_lshlrev_b32 v73, 16, v57
    v_dot2c_f32_bf16 v64, v152, v72
    v_dot2c_f32_bf16 v65, v152, v73
    v_dot2c_f32_bf16 v66, v153, v72
    v_dot2c_f32_bf16 v67, v153, v73
    v_dot2c_f32_bf16 v68, v154, v72
    v_dot2c_f32_bf16 v69, v154, v73
    v_dot2c_f32_bf16 v70, v155, v72
    v_dot2c_f32_bf16 v71, v155, v73
    v_lshrrev_b32 v74, 16, v57
    v_and_b32 v75, 0xffff0000, v57
    v_dot2c_f32_bf16 v64, v156, v74
    v_dot2c_f32_bf16 v65, v156, v75
    v_dot2c_f32_bf16 v66, v157, v74
    v_dot2c_f32_bf16 v67, v157, v75
    v_dot2c_f32_bf16 v68, v158, v74
    v_dot2c_f32_bf16 v69, v158, v75
    v_dot2c_f32_bf16 v70, v159, v74
    v_dot2c_f32_bf16 v71, v159, v75
    s_waitcnt vmcnt(8)
    v_and_b32 v72, 0xffff, v58
    v_lshlrev_b32 v73, 16, v58
    v_dot2c_f32_bf16 v64, v160, v72
    v_dot2c_f32_bf16 v65, v160, v73
    v_dot2c_f32_bf16 v66, v161, v72
    v_dot2c_f32_bf16 v67, v161, v73
    v_dot2c_f32_bf16 v68, v162, v72
    v_dot2c_f32_bf16 v69, v162, v73
    v_dot2c_f32_bf16 v70, v163, v72
    v_dot2c_f32_bf16 v71, v163, v73
    v_lshrrev_b32 v74, 16, v58
    v_and_b32 v75, 0xffff0000, v58
    v_dot2c_f32_bf16 v64, v164, v74
    v_dot2c_f32_bf16 v65, v164, v75
    v_dot2c_f32_bf16 v66, v165, v74
    v_dot2c_f32_bf16 v67, v165, v75
    v_dot2c_f32_bf16 v68, v166, v74
    v_dot2c_f32_bf16 v69, v166, v75
    v_dot2c_f32_bf16 v70, v167, v74
    v_dot2c_f32_bf16 v71, v167, v75
    v_and_b32 v72, 0xffff, v59
    v_lshlrev_b32 v73, 16, v59
    v_dot2c_f32_bf16 v64, v168, v72
    v_dot2c_f32_bf16 v65, v168, v73
    v_dot2c_f32_bf16 v66, v169, v72
    v_dot2c_f32_bf16 v67, v169, v73
    v_dot2c_f32_bf16 v68, v170, v72
    v_dot2c_f32_bf16 v69, v170, v73
    v_dot2c_f32_bf16 v70, v171, v72
    v_dot2c_f32_bf16 v71, v171, v73
    v_lshrrev_b32 v74, 16, v59
    v_and_b32 v75, 0xffff0000, v59
    v_dot2c_f32_bf16 v64, v172, v74
    v_dot2c_f32_bf16 v65, v172, v75
    v_dot2c_f32_bf16 v66, v173, v74
    v_dot2c_f32_bf16 v67, v173, v75
    v_dot2c_f32_bf16 v68, v174, v74
    v_dot2c_f32_bf16 v69, v174, v75
    v_dot2c_f32_bf16 v70, v175, v74
    v_dot2c_f32_bf16 v71, v175, v75
    s_waitcnt vmcnt(4)
    v_and_b32 v72, 0xffff, v60
    v_lshlrev_b32 v73, 16, v60
    v_dot2c_f32_bf16 v64, v176, v72
    v_dot2c_f32_bf16 v65, v176, v73
    v_dot2c_f32_bf16 v66, v177, v72
    v_dot2c_f32_bf16 v67, v177, v73
    v_dot2c_f32_bf16 v68, v178, v72
    v_dot2c_f32_bf16 v69, v178, v73
    v_dot2c_f32_bf16 v70, v179, v72
    v_dot2c_f32_bf16 v71, v179, v73
    v_lshrrev_b32 v74, 16, v60
    v_and_b32 v75, 0xffff0000, v60
    v_dot2c_f32_bf16 v64, v180, v74
    v_dot2c_f32_bf16 v65, v180, v75
    v_dot2c_f32_bf16 v66, v181, v74
    v_dot2c_f32_bf16 v67, v181, v75
    v_dot2c_f32_bf16 v68, v182, v74
    v_dot2c_f32_bf16 v69, v182, v75
    v_dot2c_f32_bf16 v70, v183, v74
    v_dot2c_f32_bf16 v71, v183, v75
    v_and_b32 v72, 0xffff, v61
    v_lshlrev_b32 v73, 16, v61
    v_dot2c_f32_bf16 v64, v184, v72
    v_dot2c_f32_bf16 v65, v184, v73
    v_dot2c_f32_bf16 v66, v185, v72
    v_dot2c_f32_bf16 v67, v185, v73
    v_dot2c_f32_bf16 v68, v186, v72
    v_dot2c_f32_bf16 v69, v186, v73
    v_dot2c_f32_bf16 v70, v187, v72
    v_dot2c_f32_bf16 v71, v187, v73
    v_lshrrev_b32 v74, 16, v61
    v_and_b32 v75, 0xffff0000, v61
    v_dot2c_f32_bf16 v64, v188, v74
    v_dot2c_f32_bf16 v65, v188, v75
    v_dot2c_f32_bf16 v66, v189, v74
    v_dot2c_f32_bf16 v67, v189, v75
    v_dot2c_f32_bf16 v68, v190, v74
    v_dot2c_f32_bf16 v69, v190, v75
    v_dot2c_f32_bf16 v70, v191, v74
    v_dot2c_f32_bf16 v71, v191, v75
    s_waitcnt vmcnt(0)
    v_and_b32 v72, 0xffff, v62
    v_lshlrev_b32 v73, 16, v62
    v_dot2c_f32_bf16 v64, v192, v72
    v_dot2c_f32_bf16 v65, v192, v73
    v_dot2c_f32_bf16 v66, v193, v72
    v_dot2c_f32_bf16 v67, v193, v73
    v_dot2c_f32_bf16 v68, v194, v72
    v_dot2c_f32_bf16 v69, v194, v73
    v_dot2c_f32_bf16 v70, v195, v72
    v_dot2c_f32_bf16 v71, v195, v73
    v_lshrrev_b32 v74, 16, v62
    v_and_b32 v75, 0xffff0000, v62
    v_dot2c_f32_bf16 v64, v196, v74
    v_dot2c_f32_bf16 v65, v196, v75
    v_dot2c_f32_bf16 v66, v197, v74
    v_dot2c_f32_bf16 v67, v197, v75
    v_dot2c_f32_bf16 v68, v198, v74
    v_dot2c_f32_bf16 v69, v198, v75
    v_dot2c_f32_bf16 v70, v199, v74
    v_dot2c_f32_bf16 v71, v199, v75
    v_and_b32 v72, 0xffff, v63
    v_lshlrev_b32 v73, 16, v63
    v_dot2c_f32_bf16 v64, v200, v72
    v_dot2c_f32_bf16 v65, v200, v73
    v_dot2c_f32_bf16 v66, v201, v72
    v_dot2c_f32_bf16 v67, v201, v73
    v_dot2c_f32_bf16 v68, v202, v72
    v_dot2c_f32_bf16 v69, v202, v73
    v_dot2c_f32_bf16 v70, v203, v72
    v_dot2c_f32_bf16 v71, v203, v73
    v_lshrrev_b32 v74, 16, v63
    v_and_b32 v75, 0xffff0000, v63
    v_dot2c_f32_bf16 v64, v204, v74
    v_dot2c_f32_bf16 v65, v204, v75
    v_dot2c_f32_bf16 v66, v205, v74
    v_dot2c_f32_bf16 v67, v205, v75
    v_dot2c_f32_bf16 v68, v206, v74
    v_dot2c_f32_bf16 v69, v206, v75
    v_dot2c_f32_bf16 v70, v207, v74
    v_dot2c_f32_bf16 v71, v207, v75
    v_permlane32_swap_b32 v64, v68
    v_permlane32_swap_b32 v65, v69
    v_permlane32_swap_b32 v66, v70
    v_permlane32_swap_b32 v67, v71
    v_add_f32 v64, v64, v68
    v_add_f32 v65, v65, v69
    v_add_f32 v66, v66, v70
    v_add_f32 v67, v67, v71
    s_nop 0
    v_permlane16_swap_b32 v64, v66
    v_permlane16_swap_b32 v65, v67
    v_add_f32 v64, v64, v66
    v_add_f32 v65, v65, v67
    ds_write_b64 v7, v[64:65] offset:0
    s_waitcnt lgkmcnt(0)
    s_mov_b64 exec, 1
    ds_add_rtn_u32 v16, v3, v15 offset:6660
    s_mov_b64 exec, -1
    s_waitcnt lgkmcnt(0)
    v_readfirstlane_b32 s48, v16
    s_nop 1
    s_cmp_lg_u32 s48, 3
    s_nop 0
    s_cbranch_scc1 L_notlast
    ds_read_b64 v[48:49], v8 offset:0
    ds_read_b64 v[50:51], v8 offset:512
    ds_read_b64 v[52:53], v8 offset:1024
    ds_read_b64 v[54:55], v8 offset:1536
    v_lshlrev_b32 v16, 2, v0
    s_waitcnt lgkmcnt(0)
    v_add_f32 v48, v48, v50
    v_add_f32 v52, v52, v54
    v_add_f32 v49, v49, v51
    v_add_f32 v53, v53, v55
    v_add_f32 v48, v48, v52
    v_add_f32 v49, v49, v53
    v_cvt_pk_bf16_f32 v48, v48, v49
    ds_write_b32 v16, v48 offset:6144
    s_waitcnt lgkmcnt(0)
    ds_write_b32 v3, v15 offset:6664
L_notlast:
    v_lshlrev_b32 v5, 4, v2
    s_mul_i32 s49, s53, 32768
    s_add_u32 s49, s49, 15360
    v_lshlrev_b32 v4, 4, v0
    v_add_u32 v4, s49, v4
    s_mov_b32 s51, 0
    s_nop 0
L_hspin:
    ds_read_b32 v16, v3 offset:6664
    ds_read_b32 v17, v13 offset:6688
    ds_read_b128 v[20:23], v5 offset:6144
    s_waitcnt lgkmcnt(0)
    v_and_b32 v16, v16, v17
    s_nop 0
    v_readfirstlane_b32 s48, v16
    s_nop 1
    s_cmp_eq_u32 s48, 1
    s_nop 0
    s_cbranch_scc1 L_hloop
    s_sleep 4
    s_branch L_hspin
L_hloop:
    ds_read_b128 v[80:83], v4 offset:0
    ds_read_b128 v[84:87], v4 offset:1024
    ds_read_b128 v[88:91], v4 offset:2048
    ds_read_b128 v[92:95], v4 offset:3072
    s_waitcnt lgkmcnt(0)
    v_dot2_f32_bf16 v32, v80, v20, 0
    v_dot2_f32_bf16 v33, v84, v20, 0
    v_dot2_f32_bf16 v34, v88, v20, 0
    v_dot2_f32_bf16 v35, v92, v20, 0
    v_dot2c_f32_bf16 v32, v81, v21
    v_dot2c_f32_bf16 v33, v85, v21
    v_dot2c_f32_bf16 v34, v89, v21
    v_dot2c_f32_bf16 v35, v93, v21
    v_dot2c_f32_bf16 v32, v82, v22
    v_dot2c_f32_bf16 v33, v86, v22
    v_dot2c_f32_bf16 v34, v90, v22
    v_dot2c_f32_bf16 v35, v94, v22
    v_dot2c_f32_bf16 v32, v83, v23
    v_dot2c_f32_bf16 v33, v87, v23
    v_dot2c_f32_bf16 v34, v91, v23
    v_dot2c_f32_bf16 v35, v95, v23
    v_add_f32_dpp v32, v32, v32 row_ror:8 row_mask:0xf bank_mask:0xf
    v_add_f32_dpp v33, v33, v33 row_ror:8 row_mask:0xf bank_mask:0xf
    v_add_f32_dpp v34, v34, v34 row_ror:8 row_mask:0xf bank_mask:0xf
    v_add_f32_dpp v35, v35, v35 row_ror:8 row_mask:0xf bank_mask:0xf
    v_add_f32_dpp v32, v32, v32 row_ror:4 row_mask:0xf bank_mask:0xf
    v_add_f32_dpp v33, v33, v33 row_ror:4 row_mask:0xf bank_mask:0xf
    v_add_f32_dpp v34, v34, v34 row_ror:4 row_mask:0xf bank_mask:0xf
    v_add_f32_dpp v35, v35, v35 row_ror:4 row_mask:0xf bank_mask:0xf
    v_add_f32_dpp v32, v32, v32 row_ror:2 row_mask:0xf bank_mask:0xf
    v_add_f32_dpp v33, v33, v33 row_ror:2 row_mask:0xf bank_mask:0xf
    v_add_f32_dpp v34, v34, v34 row_ror:2 row_mask:0xf bank_mask:0xf
    v_add_f32_dpp v35, v35, v35 row_ror:2 row_mask:0xf bank_mask:0xf
    v_add_f32_dpp v32, v32, v32 row_ror:1 row_mask:0xf bank_mask:0xf
    v_add_f32_dpp v33, v33, v33 row_ror:1 row_mask:0xf bank_mask:0xf
    v_add_f32_dpp v34, v34, v34 row_ror:1 row_mask:0xf bank_mask:0xf
    v_add_f32_dpp v35, v35, v35 row_ror:1 row_mask:0xf bank_mask:0xf
    s_mov_b64 exec, s[86:87]
    ds_write_b128 v12, v[32:35] offset:0
    s_mov_b64 exec, -1
    v_max3_f32 v11, v11, v32, v33
    v_max3_f32 v11, v11, v34, v35
    v_add_u32 v4, 0x1000, v4
    v_add_u32 v12, 64, v12
    s_add_u32 s51, s51, 1
    s_cmp_lt_u32 s51, 8
    s_cbranch_scc1 L_hloop
    v_lshlrev_b32 v17, 2, v1
    v_lshl_add_u32 v17, v13, 2, v17
    ds_write_b32 v17, v11 offset:6848
    s_waitcnt lgkmcnt(0)
    ds_write_b32 v13, v15 offset:6704
    s_sub_u32 s51, s2, 8
    s_cmp_ge_u32 s51, 16
    s_cbranch_scc1 L_noclr
    s_lshl_b32 s48, s51, 2
    s_add_u32 s48, s48, s53
    s_mul_i32 s49, s48, 64
    s_add_u32 s49, s49, 0x80000
    s_mul_i32 s48, s48, 8192
    v_mov_b32 v48, -1
    v_mov_b32 v49, -1
    v_mov_b32 v50, -1
    v_mov_b32 v51, -1
    v_lshlrev_b32 v5, 4, v0
    buffer_store_dwordx4 v[48:51], v5, s[40:43], s48 offen sc1
    s_add_u32 s48, s48, 1024
    buffer_store_dwordx4 v[48:51], v5, s[40:43], s48 offen sc1
    s_add_u32 s48, s48, 1024
    s_waitcnt vmcnt(1)
    buffer_store_dwordx4 v[48:51], v5, s[40:43], s48 offen sc1
    s_add_u32 s48, s48, 1024
    s_waitcnt vmcnt(1)
    buffer_store_dwordx4 v[48:51], v5, s[40:43], s48 offen sc1
    s_add_u32 s48, s48, 1024
    s_waitcnt vmcnt(1)
    buffer_store_dwordx4 v[48:51], v5, s[40:43], s48 offen sc1
    s_add_u32 s48, s48, 1024
    s_waitcnt vmcnt(1)
    buffer_store_dwordx4 v[48:51], v5, s[40:43], s48 offen sc1
    s_add_u32 s48, s48, 1024
    s_waitcnt vmcnt(1)
    buffer_store_dwordx4 v[48:51], v5, s[40:43], s48 offen sc1
    s_add_u32 s48, s48, 1024
    s_waitcnt vmcnt(1)
    buffer_store_dwordx4 v[48:51], v5, s[40:43], s48 offen sc1
    s_add_u32 s48, s48, 1024
    s_mov_b32 exec_lo, 0xf
    s_mov_b32 exec_hi, 0x0
    buffer_store_dwordx4 v[48:51], v5, s[40:43], s49 offen sc1
    s_mov_b64 exec, 1
    s_waitcnt vmcnt(0)
    ds_add_rtn_u32 v52, v3, v15 offset:6656
    s_waitcnt lgkmcnt(0)
    v_readfirstlane_b32 s48, v52
    s_nop 1
    s_cmp_lg_u32 s48, 3
    s_nop 0
    s_cbranch_scc1 L_noflag
    s_lshl_b32 s48, s51, 2
    buffer_store_dword v15, v3, s[56:59], s48 offen sc1
L_noflag:
    s_mov_b64 exec, -1
L_noclr:
    v_lshlrev_b32 v5, 15, v1
    v_lshl_add_u32 v5, v2, 4, v5
    s_lshl_b32 s48, s53, 8
    v_add_u32 v5, s48, v5
    s_mov_b32 s48, 0
    buffer_load_dwordx4 v[80:83], v5, s[32:35], s48 offen offset:0
    buffer_load_dwordx4 v[84:87], v5, s[32:35], s48 offen offset:1024
    s_waitcnt vmcnt(1)
    buffer_load_dwordx4 v[88:91], v5, s[32:35], s48 offen offset:2048
    s_waitcnt vmcnt(1)
    buffer_load_dwordx4 v[92:95], v5, s[32:35], s48 offen offset:3072
    s_mov_b32 s48, 4096
    s_waitcnt vmcnt(1)
    buffer_load_dwordx4 v[96:99], v5, s[32:35], s48 offen offset:0
    s_waitcnt vmcnt(1)
    buffer_load_dwordx4 v[100:103], v5, s[32:35], s48 offen offset:1024
    s_waitcnt vmcnt(1)
    buffer_load_dwordx4 v[104:107], v5, s[32:35], s48 offen offset:2048
    s_waitcnt vmcnt(1)
    buffer_load_dwordx4 v[108:111], v5, s[32:35], s48 offen offset:3072
    s_mov_b32 s48, 8192
    s_waitcnt vmcnt(1)
    buffer_load_dwordx4 v[112:115], v5, s[32:35], s48 offen offset:0
    s_lshl_b32 s51, s46, 5
    s_add_u32 s51, s51, s45
    s_lshl_b32 s51, s51, 20
    s_lshl_b32 s49, s47, 19
    s_add_u32 s51, s51, s49
    s_add_u32 s36, s8, s51
    s_addc_u32 s37, s9, 0
    s_mov_b32 s38, 0x80000
    s_lshl_b32 s49, s53, 17
    s_mov_b64 exec, 1
    buffer_load_dword v16, v3, s[36:39], s49 offen nt
    s_mov_b64 exec, -1
    s_waitcnt vmcnt(1)
    buffer_load_dwordx4 v[116:119], v5, s[32:35], s48 offen offset:1024
    s_waitcnt vmcnt(1)
    buffer_load_dwordx4 v[120:123], v5, s[32:35], s48 offen offset:2048
    s_waitcnt vmcnt(1)
    buffer_load_dwordx4 v[124:127], v5, s[32:35], s48 offen offset:3072
    s_mov_b32 s48, 12288
    s_waitcnt vmcnt(1)
    buffer_load_dwordx4 v[128:131], v5, s[32:35], s48 offen offset:0
    s_waitcnt vmcnt(1)
    buffer_load_dwordx4 v[132:135], v5, s[32:35], s48 offen offset:1024
    s_waitcnt vmcnt(1)
    buffer_load_dwordx4 v[136:139], v5, s[32:35], s48 offen offset:2048
    s_waitcnt vmcnt(1)
    buffer_load_dwordx4 v[140:143], v5, s[32:35], s48 offen offset:3072
    s_mov_b32 s48, 16384
    s_waitcnt vmcnt(1)
    buffer_load_dwordx4 v[144:147], v5, s[32:35], s48 offen offset:0
    s_waitcnt vmcnt(1)
    buffer_load_dwordx4 v[148:151], v5, s[32:35], s48 offen offset:1024
    s_waitcnt vmcnt(1)
    buffer_load_dwordx4 v[152:155], v5, s[32:35], s48 offen offset:2048
    s_waitcnt vmcnt(1)
    buffer_load_dwordx4 v[156:159], v5, s[32:35], s48 offen offset:3072
    s_mov_b32 s48, 20480
    s_waitcnt vmcnt(1)
    buffer_load_dwordx4 v[160:163], v5, s[32:35], s48 offen offset:0
    s_waitcnt vmcnt(1)
    buffer_load_dwordx4 v[164:167], v5, s[32:35], s48 offen offset:1024
    s_waitcnt vmcnt(1)
    buffer_load_dwordx4 v[168:171], v5, s[32:35], s48 offen offset:2048
    s_waitcnt vmcnt(1)
    buffer_load_dwordx4 v[172:175], v5, s[32:35], s48 offen offset:3072
    s_mov_b32 s48, 24576
    s_waitcnt vmcnt(1)
    buffer_load_dwordx4 v[176:179], v5, s[32:35], s48 offen offset:0
    s_waitcnt vmcnt(1)
    buffer_load_dwordx4 v[180:183], v5, s[32:35], s48 offen offset:1024
    s_waitcnt vmcnt(1)
    buffer_load_dwordx4 v[184:187], v5, s[32:35], s48 offen offset:2048
    s_waitcnt vmcnt(1)
    buffer_load_dwordx4 v[188:191], v5, s[32:35], s48 offen offset:3072
    s_mov_b32 s48, 28672
    s_waitcnt vmcnt(1)
    buffer_load_dwordx4 v[192:195], v5, s[32:35], s48 offen offset:0
    s_waitcnt vmcnt(1)
    buffer_load_dwordx4 v[196:199], v5, s[32:35], s48 offen offset:1024
    s_waitcnt vmcnt(1)
    buffer_load_dwordx4 v[200:203], v5, s[32:35], s48 offen offset:2048
    s_waitcnt vmcnt(1)
    buffer_load_dwordx4 v[204:207], v5, s[32:35], s48 offen offset:3072
    s_mov_b32 s48, 0x05040100
    s_mov_b32 s49, 0x07060302
    s_waitcnt vmcnt(0)
    v_perm_b32 v208, v84, v80, s48
    v_perm_b32 v84, v84, v80, s49
    v_perm_b32 v80, v85, v81, s48
    v_perm_b32 v85, v85, v81, s49
    v_perm_b32 v81, v86, v82, s48
    v_perm_b32 v86, v86, v82, s49
    v_perm_b32 v82, v87, v83, s48
    v_perm_b32 v87, v87, v83, s49
    v_perm_b32 v83, v92, v88, s48
    v_perm_b32 v92, v92, v88, s49
    v_perm_b32 v88, v93, v89, s48
    v_perm_b32 v93, v93, v89, s49
    v_perm_b32 v89, v94, v90, s48
    v_perm_b32 v94, v94, v90, s49
    v_perm_b32 v90, v95, v91, s48
    v_perm_b32 v95, v95, v91, s49
    v_perm_b32 v91, v100, v96, s48
    v_perm_b32 v100, v100, v96, s49
    v_perm_b32 v96, v101, v97, s48
    v_perm_b32 v101, v101, v97, s49
    v_perm_b32 v97, v102, v98, s48
    v_perm_b32 v102, v102, v98, s49
    v_perm_b32 v98, v103, v99, s48
    v_perm_b32 v103, v103, v99, s49
    v_perm_b32 v99, v108, v104, s48
    v_perm_b32 v108, v108, v104, s49
    v_perm_b32 v104, v109, v105, s48
    v_perm_b32 v109, v109, v105, s49
    v_perm_b32 v105, v110, v106, s48
    v_perm_b32 v110, v110, v106, s49
    v_perm_b32 v106, v111, v107, s48
    v_perm_b32 v111, v111, v107, s49
    v_perm_b32 v107, v116, v112, s48
    v_perm_b32 v116, v116, v112, s49
    v_perm_b32 v112, v117, v113, s48
    v_perm_b32 v117, v117, v113, s49
    v_perm_b32 v113, v118, v114, s48
    v_perm_b32 v118, v118, v114, s49
    v_perm_b32 v114, v119, v115, s48
    v_perm_b32 v119, v119, v115, s49
    v_perm_b32 v115, v124, v120, s48
    v_perm_b32 v124, v124, v120, s49
    v_perm_b32 v120, v125, v121, s48
    v_perm_b32 v125, v125, v121, s49
    v_perm_b32 v121, v126, v122, s48
    v_perm_b32 v126, v126, v122, s49
    v_perm_b32 v122, v127, v123, s48
    v_perm_b32 v127, v127, v123, s49
    v_perm_b32 v123, v132, v128, s48
    v_perm_b32 v132, v132, v128, s49
    v_perm_b32 v128, v133, v129, s48
    v_perm_b32 v133, v133, v129, s49
    v_perm_b32 v129, v134, v130, s48
    v_perm_b32 v134, v134, v130, s49
    v_perm_b32 v130, v135, v131, s48
    v_perm_b32 v135, v135, v131, s49
    v_perm_b32 v131, v140, v136, s48
    v_perm_b32 v140, v140, v136, s49
    v_perm_b32 v136, v141, v137, s48
    v_perm_b32 v141, v141, v137, s49
    v_perm_b32 v137, v142, v138, s48
    v_perm_b32 v142, v142, v138, s49
    v_perm_b32 v138, v143, v139, s48
    v_perm_b32 v143, v143, v139, s49
    v_perm_b32 v139, v148, v144, s48
    v_perm_b32 v148, v148, v144, s49
    v_perm_b32 v144, v149, v145, s48
    v_perm_b32 v149, v149, v145, s49
    v_perm_b32 v145, v150, v146, s48
    v_perm_b32 v150, v150, v146, s49
    v_perm_b32 v146, v151, v147, s48
    v_perm_b32 v151, v151, v147, s49
    v_perm_b32 v147, v156, v152, s48
    v_perm_b32 v156, v156, v152, s49
    v_perm_b32 v152, v157, v153, s48
    v_perm_b32 v157, v157, v153, s49
    v_perm_b32 v153, v158, v154, s48
    v_perm_b32 v158, v158, v154, s49
    v_perm_b32 v154, v159, v155, s48
    v_perm_b32 v159, v159, v155, s49
    v_perm_b32 v155, v164, v160, s48
    v_perm_b32 v164, v164, v160, s49
    v_perm_b32 v160, v165, v161, s48
    v_perm_b32 v165, v165, v161, s49
    v_perm_b32 v161, v166, v162, s48
    v_perm_b32 v166, v166, v162, s49
    v_perm_b32 v162, v167, v163, s48
    v_perm_b32 v167, v167, v163, s49
    v_perm_b32 v163, v172, v168, s48
    v_perm_b32 v172, v172, v168, s49
    v_perm_b32 v168, v173, v169, s48
    v_perm_b32 v173, v173, v169, s49
    v_perm_b32 v169, v174, v170, s48
    v_perm_b32 v174, v174, v170, s49
    v_perm_b32 v170, v175, v171, s48
    v_perm_b32 v175, v175, v171, s49
    v_perm_b32 v171, v180, v176, s48
    v_perm_b32 v180, v180, v176, s49
    v_perm_b32 v176, v181, v177, s48
    v_perm_b32 v181, v181, v177, s49
    v_perm_b32 v177, v182, v178, s48
    v_perm_b32 v182, v182, v178, s49
    v_perm_b32 v178, v183, v179, s48
    v_perm_b32 v183, v183, v179, s49
    v_perm_b32 v179, v188, v184, s48
    v_perm_b32 v188, v188, v184, s49
    v_perm_b32 v184, v189, v185, s48
    v_perm_b32 v189, v189, v185, s49
    v_perm_b32 v185, v190, v186, s48
    v_perm_b32 v190, v190, v186, s49
    v_perm_b32 v186, v191, v187, s48
    v_perm_b32 v191, v191, v187, s49
    v_perm_b32 v187, v196, v192, s48
    v_perm_b32 v196, v196, v192, s49
    v_perm_b32 v192, v197, v193, s48
    v_perm_b32 v197, v197, v193, s49
    v_perm_b32 v193, v198, v194, s48
    v_perm_b32 v198, v198, v194, s49
    v_perm_b32 v194, v199, v195, s48
    v_perm_b32 v199, v199, v195, s49
    v_perm_b32 v195, v204, v200, s48
    v_perm_b32 v204, v204, v200, s49
    v_perm_b32 v200, v205, v201, s48
    v_perm_b32 v205, v205, v201, s49
    v_perm_b32 v201, v206, v202, s48
    v_perm_b32 v206, v206, v202, s49
    v_perm_b32 v202, v207, v203, s48
    v_perm_b32 v207, v207, v203, s49
    s_lshl_b32 s48, s53, 11
    s_add_u32 s48, s48, 7168
    v_lshlrev_b32 v4, 5, v0
    v_add_u32 v4, s48, v4
    s_nop 1
L_kspin:
    ds_read_b32 v16, v13 offset:6720
    ds_read_b128 v[48:51], v4
    ds_read_b128 v[52:55], v4 offset:16
    s_waitcnt lgkmcnt(0)
    v_readfirstlane_b32 s48, v16
    s_nop 1
    s_cmp_eq_u32 s48, 1
    s_nop 0
    s_cbranch_scc1 L_kgo
    s_sleep 8
    s_branch L_kspin
L_kgo:
    v_max3_f32 v16, v48, v49, v50
    v_max3_f32 v16, v16, v51, v52
    v_max3_f32 v16, v16, v53, v54
    v_max_f32 v16, v16, v55
    s_nop 1
    v_max_f32_dpp v16, v16, v16 row_ror:8 row_mask:0xf bank_mask:0xf
    s_nop 1
    v_max_f32_dpp v16, v16, v16 row_ror:4 row_mask:0xf bank_mask:0xf
    s_nop 1
    v_max_f32_dpp v16, v16, v16 row_ror:2 row_mask:0xf bank_mask:0xf
    s_nop 1
    v_max_f32_dpp v16, v16, v16 row_ror:1 row_mask:0xf bank_mask:0xf
    v_mov_b32 v14, v16
    s_nop 1
    v_permlane16_swap_b32 v16, v14
    s_nop 0
    v_max_f32 v16, v16, v14
    v_mov_b32 v14, v16
    s_nop 1
    v_permlane32_swap_b32 v16, v14
    s_nop 0
    v_max_f32 v16, v16, v14
    v_mul_f32 v16, s50, v16
    v_fma_f32 v48, v48, s50, -v16
    v_fma_f32 v49, v49, s50, -v16
    v_fma_f32 v50, v50, s50, -v16
    v_fma_f32 v51, v51, s50, -v16
    v_fma_f32 v52, v52, s50, -v16
    v_fma_f32 v53, v53, s50, -v16
    v_fma_f32 v54, v54, s50, -v16
    v_fma_f32 v55, v55, s50, -v16
    v_exp_f32 v48, v48
    v_exp_f32 v49, v49
    v_exp_f32 v50, v50
    v_exp_f32 v51, v51
    v_exp_f32 v52, v52
    v_exp_f32 v53, v53
    v_exp_f32 v54, v54
    v_exp_f32 v55, v55
    v_add_f32 v48, v48, v52
    v_add_f32 v49, v49, v53
    v_add_f32 v50, v50, v54
    v_add_f32 v51, v51, v55
    v_add_f32 v48, v48, v50
    v_add_f32 v49, v49, v51
    v_add_f32 v48, v48, v49
    v_mov_b32 v17, v48
    s_nop 1
    v_add_f32_dpp v17, v17, v17 row_ror:8 row_mask:0xf bank_mask:0xf
    s_nop 1
    v_add_f32_dpp v17, v17, v17 row_ror:4 row_mask:0xf bank_mask:0xf
    s_nop 1
    v_add_f32_dpp v17, v17, v17 row_ror:2 row_mask:0xf bank_mask:0xf
    s_nop 1
    v_add_f32_dpp v17, v17, v17 row_ror:1 row_mask:0xf bank_mask:0xf
    v_mov_b32 v14, v17
    s_nop 1
    v_permlane16_swap_b32 v17, v14
    s_nop 0
    v_add_f32 v17, v17, v14
    v_mov_b32 v14, v17
    s_nop 1
    v_permlane32_swap_b32 v17, v14
    s_nop 0
    v_add_f32 v17, v17, v14
    v_lshlrev_b32 v14, 1, v13
    ds_write_b64 v14, v[16:17] offset:6784
    s_waitcnt lgkmcnt(0)
    s_mov_b64 exec, 1
    ds_add_rtn_u32 v16, v3, v15 offset:6668
    s_mov_b64 exec, -1
    s_waitcnt lgkmcnt(0)
    v_readfirstlane_b32 s48, v16
    s_nop 1
    s_cmp_lg_u32 s48, 3
    s_nop 0
    s_cbranch_scc1 L_b2
    ds_read_b128 v[48:51], v3 offset:6784
    ds_read_b128 v[52:55], v3 offset:6800
    v_lshlrev_b32 v57, 2, v0
    s_waitcnt lgkmcnt(0)
    v_max3_f32 v17, v48, v50, v52
    v_max_f32 v17, v17, v54
    v_mov_b32 v16, 1
    ds_write_b64 v3, v[16:17] offset:6672
    v_sub_f32 v48, v48, v17
    v_sub_f32 v50, v50, v17
    v_sub_f32 v52, v52, v17
    v_sub_f32 v54, v54, v17
    v_exp_f32 v48, v48
    v_exp_f32 v50, v50
    v_exp_f32 v52, v52
    v_exp_f32 v54, v54
    v_mul_f32 v14, v48, v49
    v_fmac_f32 v14, v50, v51
    v_fmac_f32 v14, v52, v53
    v_fmac_f32 v14, v54, v55
    v_min_u32 v58, -2, v17
    v_min_u32 v59, -2, v14
    s_mov_b32 exec_lo, 0xffff
    s_mov_b32 exec_hi, 0x0
L_cnt:
    buffer_load_dword v56, v57, s[56:59], 0 offen sc1
    s_waitcnt vmcnt(0)
    v_cmp_ne_u32 vcc, 1, v56
    s_nop 3
    s_cbranch_vccz L_cntok
    s_sleep 64
    s_branch L_cnt
L_cntok:
    s_mov_b64 exec, 1
    s_lshr_b32 s48, s54, 3
    s_lshl_b32 s48, s48, 7
    s_and_b32 s49, s54, 7
    s_lshl_b32 s49, s49, 3
    s_add_u32 s48, s48, s49
    s_add_u32 s48, s48, 0x80000
    buffer_store_dwordx2 v[58:59], v3, s[40:43], s48 offen sc1
    s_mov_b64 exec, -1
    s_cmp_lg_u32 s88, 0
    s_cbranch_scc1 L_b2
    v_lshrrev_b32 v16, 3, v0
    v_lshlrev_b32 v16, 7, v16
    v_and_b32 v17, 7, v0
    v_lshl_add_u32 v16, v17, 3, v16
    s_lshl_b32 s49, s84, 10
    s_add_u32 s49, s49, 0x80000
L_wpoll:
    buffer_load_dwordx2 v[48:49], v16, s[40:43], s49 offen sc1
    s_waitcnt vmcnt(0)
    v_max_u32 v17, v48, v49
    v_cmp_eq_u32 vcc, -1, v17
    s_nop 1
    s_and_b64 exec, exec, vcc
    s_nop 0
    s_cbranch_execz L_wgot
    s_sleep 32
    s_branch L_wpoll
L_wgot:
    s_mov_b64 exec, -1
    v_max_f32_dpp v17, v48, v48 quad_perm:[1,0,3,2] row_mask:0xf bank_mask:0xf
    v_sub_f32 v17, v48, v17
    v_exp_f32 v17, v17
    s_nop 0
    v_mul_f32 v49, v49, v17
    s_nop 1
    v_add_f32_dpp v50, v49, v49 quad_perm:[1,0,3,2] row_mask:0xf bank_mask:0xf
    v_rcp_f32 v50, v50
    s_nop 0
    v_mul_f32 v17, v17, v50
    ds_write_b32 v57, v17 offset:6400
    s_waitcnt lgkmcnt(0)
L_b2:
    s_barrier
    ds_read_b64 v[48:49], v8 offset:2048
    ds_read_b64 v[50:51], v8 offset:2560
    ds_read_b64 v[52:53], v8 offset:3072
    ds_read_b64 v[54:55], v8 offset:3584
    s_waitcnt lgkmcnt(0)
    v_add_f32 v48, v48, v50
    v_add_f32 v52, v52, v54
    v_add_f32 v49, v49, v51
    v_add_f32 v53, v53, v55
    v_add_f32 v48, v48, v52
    v_add_f32 v49, v49, v53
    v_cvt_pk_bf16_f32 v48, v48, v49
    ds_write_b32 v9, v48
    s_waitcnt lgkmcnt(0)
    ds_read_b128 v[56:59], v10 offset:0
    ds_read_b128 v[60:63], v10 offset:16
    ds_read_b128 v[64:67], v10 offset:32
    ds_read_b128 v[68:71], v10 offset:48
    s_waitcnt lgkmcnt(3)
    v_dot2_f32_bf16 v24, v208, v56, 0
    v_dot2_f32_bf16 v25, v84, v56, 0
    v_dot2_f32_bf16 v26, v80, v56, 0
    v_dot2_f32_bf16 v27, v85, v56, 0
    v_dot2_f32_bf16 v28, v81, v56, 0
    v_dot2_f32_bf16 v29, v86, v56, 0
    v_dot2_f32_bf16 v30, v82, v56, 0
    v_dot2_f32_bf16 v31, v87, v56, 0
    v_dot2c_f32_bf16 v24, v83, v57
    v_dot2c_f32_bf16 v25, v92, v57
    v_dot2c_f32_bf16 v26, v88, v57
    v_dot2c_f32_bf16 v27, v93, v57
    v_dot2c_f32_bf16 v28, v89, v57
    v_dot2c_f32_bf16 v29, v94, v57
    v_dot2c_f32_bf16 v30, v90, v57
    v_dot2c_f32_bf16 v31, v95, v57
    v_dot2c_f32_bf16 v24, v91, v58
    v_dot2c_f32_bf16 v25, v100, v58
    v_dot2c_f32_bf16 v26, v96, v58
    v_dot2c_f32_bf16 v27, v101, v58
    v_dot2c_f32_bf16 v28, v97, v58
    v_dot2c_f32_bf16 v29, v102, v58
    v_dot2c_f32_bf16 v30, v98, v58
    v_dot2c_f32_bf16 v31, v103, v58
    v_dot2c_f32_bf16 v24, v99, v59
    v_dot2c_f32_bf16 v25, v108, v59
    v_dot2c_f32_bf16 v26, v104, v59
    v_dot2c_f32_bf16 v27, v109, v59
    v_dot2c_f32_bf16 v28, v105, v59
    v_dot2c_f32_bf16 v29, v110, v59
    v_dot2c_f32_bf16 v30, v106, v59
    v_dot2c_f32_bf16 v31, v111, v59
    s_waitcnt lgkmcnt(2)
    v_dot2c_f32_bf16 v24, v107, v60
    v_dot2c_f32_bf16 v25, v116, v60
    v_dot2c_f32_bf16 v26, v112, v60
    v_dot2c_f32_bf16 v27, v117, v60
    v_dot2c_f32_bf16 v28, v113, v60
    v_dot2c_f32_bf16 v29, v118, v60
    v_dot2c_f32_bf16 v30, v114, v60
    v_dot2c_f32_bf16 v31, v119, v60
    v_dot2c_f32_bf16 v24, v115, v61
    v_dot2c_f32_bf16 v25, v124, v61
    v_dot2c_f32_bf16 v26, v120, v61
    v_dot2c_f32_bf16 v27, v125, v61
    v_dot2c_f32_bf16 v28, v121, v61
    v_dot2c_f32_bf16 v29, v126, v61
    v_dot2c_f32_bf16 v30, v122, v61
    v_dot2c_f32_bf16 v31, v127, v61
    v_dot2c_f32_bf16 v24, v123, v62
    v_dot2c_f32_bf16 v25, v132, v62
    v_dot2c_f32_bf16 v26, v128, v62
    v_dot2c_f32_bf16 v27, v133, v62
    v_dot2c_f32_bf16 v28, v129, v62
    v_dot2c_f32_bf16 v29, v134, v62
    v_dot2c_f32_bf16 v30, v130, v62
    v_dot2c_f32_bf16 v31, v135, v62
    v_dot2c_f32_bf16 v24, v131, v63
    v_dot2c_f32_bf16 v25, v140, v63
    v_dot2c_f32_bf16 v26, v136, v63
    v_dot2c_f32_bf16 v27, v141, v63
    v_dot2c_f32_bf16 v28, v137, v63
    v_dot2c_f32_bf16 v29, v142, v63
    v_dot2c_f32_bf16 v30, v138, v63
    v_dot2c_f32_bf16 v31, v143, v63
    s_waitcnt lgkmcnt(1)
    v_dot2c_f32_bf16 v24, v139, v64
    v_dot2c_f32_bf16 v25, v148, v64
    v_dot2c_f32_bf16 v26, v144, v64
    v_dot2c_f32_bf16 v27, v149, v64
    v_dot2c_f32_bf16 v28, v145, v64
    v_dot2c_f32_bf16 v29, v150, v64
    v_dot2c_f32_bf16 v30, v146, v64
    v_dot2c_f32_bf16 v31, v151, v64
    v_dot2c_f32_bf16 v24, v147, v65
    v_dot2c_f32_bf16 v25, v156, v65
    v_dot2c_f32_bf16 v26, v152, v65
    v_dot2c_f32_bf16 v27, v157, v65
    v_dot2c_f32_bf16 v28, v153, v65
    v_dot2c_f32_bf16 v29, v158, v65
    v_dot2c_f32_bf16 v30, v154, v65
    v_dot2c_f32_bf16 v31, v159, v65
    v_dot2c_f32_bf16 v24, v155, v66
    v_dot2c_f32_bf16 v25, v164, v66
    v_dot2c_f32_bf16 v26, v160, v66
    v_dot2c_f32_bf16 v27, v165, v66
    v_dot2c_f32_bf16 v28, v161, v66
    v_dot2c_f32_bf16 v29, v166, v66
    v_dot2c_f32_bf16 v30, v162, v66
    v_dot2c_f32_bf16 v31, v167, v66
    v_dot2c_f32_bf16 v24, v163, v67
    v_dot2c_f32_bf16 v25, v172, v67
    v_dot2c_f32_bf16 v26, v168, v67
    v_dot2c_f32_bf16 v27, v173, v67
    v_dot2c_f32_bf16 v28, v169, v67
    v_dot2c_f32_bf16 v29, v174, v67
    v_dot2c_f32_bf16 v30, v170, v67
    v_dot2c_f32_bf16 v31, v175, v67
    s_waitcnt lgkmcnt(0)
    v_dot2c_f32_bf16 v24, v171, v68
    v_dot2c_f32_bf16 v25, v180, v68
    v_dot2c_f32_bf16 v26, v176, v68
    v_dot2c_f32_bf16 v27, v181, v68
    v_dot2c_f32_bf16 v28, v177, v68
    v_dot2c_f32_bf16 v29, v182, v68
    v_dot2c_f32_bf16 v30, v178, v68
    v_dot2c_f32_bf16 v31, v183, v68
    v_dot2c_f32_bf16 v24, v179, v69
    v_dot2c_f32_bf16 v25, v188, v69
    v_dot2c_f32_bf16 v26, v184, v69
    v_dot2c_f32_bf16 v27, v189, v69
    v_dot2c_f32_bf16 v28, v185, v69
    v_dot2c_f32_bf16 v29, v190, v69
    v_dot2c_f32_bf16 v30, v186, v69
    v_dot2c_f32_bf16 v31, v191, v69
    v_dot2c_f32_bf16 v24, v187, v70
    v_dot2c_f32_bf16 v25, v196, v70
    v_dot2c_f32_bf16 v26, v192, v70
    v_dot2c_f32_bf16 v27, v197, v70
    v_dot2c_f32_bf16 v28, v193, v70
    v_dot2c_f32_bf16 v29, v198, v70
    v_dot2c_f32_bf16 v30, v194, v70
    v_dot2c_f32_bf16 v31, v199, v70
    v_dot2c_f32_bf16 v24, v195, v71
    v_dot2c_f32_bf16 v25, v204, v71
    v_dot2c_f32_bf16 v26, v200, v71
    v_dot2c_f32_bf16 v27, v205, v71
    v_dot2c_f32_bf16 v28, v201, v71
    v_dot2c_f32_bf16 v29, v206, v71
    v_dot2c_f32_bf16 v30, v202, v71
    v_dot2c_f32_bf16 v31, v207, v71
    v_permlane32_swap_b32 v24, v28
    v_permlane32_swap_b32 v25, v29
    v_permlane32_swap_b32 v26, v30
    v_permlane32_swap_b32 v27, v31
    v_add_f32 v24, v24, v28
    v_add_f32 v25, v25, v29
    v_add_f32 v26, v26, v30
    v_add_f32 v27, v27, v31
    v_mov_b32 v28, v24
    v_mov_b32 v29, v25
    v_mov_b32 v30, v26
    v_mov_b32 v31, v27
    v_permlane16_swap_b32 v24, v28
    v_permlane16_swap_b32 v25, v29
    v_permlane16_swap_b32 v26, v30
    v_permlane16_swap_b32 v27, v31
    v_add_f32 v24, v24, v28
    v_add_f32 v25, v25, v29
    v_add_f32 v26, v26, v30
    v_add_f32 v27, v27, v31
    v_min_u32 v24, -2, v24
    v_min_u32 v25, -2, v25
    v_min_u32 v26, -2, v26
    v_min_u32 v27, -2, v27
    s_mov_b32 exec_lo, 0xffff
    s_mov_b32 exec_hi, 0xffff
    buffer_store_dwordx4 v[24:27], v6, s[40:43], s55 offen sc1
    s_mov_b64 exec, -1
    s_nop 0
L_cons:
    s_cmp_lg_u32 s88, 0
    s_cbranch_scc1 L_fin
    v_lshrrev_b32 v54, 3, v0
    v_lshlrev_b32 v52, 11, v54
    v_and_b32 v55, 7, v0
    v_lshl_add_u32 v52, v55, 4, v52
    s_lshl_b32 s48, s44, 5
    v_lshl_add_u32 v54, v54, 2, s48
    ds_read_b32 v53, v54 offset:6400
    s_lshl_b32 s48, s84, 17
    s_lshl_b32 s49, s44, 14
    s_add_u32 s48, s48, s49
    s_lshl_b32 s49, s85, 7
    s_add_u32 s48, s48, s49
    v_lshlrev_b32 v55, 4, v55
    v_lshl_add_u32 v55, v1, 2, v55
    s_lshl_b32 s49, s44, 7
    v_add_u32 v55, s49, v55
    s_nop 1
L_poll:
    buffer_load_dwordx4 v[48:51], v52, s[40:43], s48 offen sc1
    s_waitcnt vmcnt(0)
    v_max3_u32 v54, v48, v49, v50
    v_max_u32 v54, v54, v51
    v_cmp_eq_u32 vcc, -1, v54
    s_nop 1
    s_and_b64 exec, exec, vcc
    s_nop 0
    s_cbranch_execz L_got
    s_sleep 1
    s_branch L_poll
L_got:
    s_mov_b64 exec, -1
    s_waitcnt lgkmcnt(0)
    v_mul_f32 v48, v48, v53
    v_mul_f32 v49, v49, v53
    v_mul_f32 v50, v50, v53
    v_mul_f32 v51, v51, v53
    s_nop 0
    v_permlane32_swap_b32 v48, v50
    v_permlane32_swap_b32 v49, v51
    v_add_f32 v48, v48, v50
    v_add_f32 v49, v49, v51
    s_nop 1
    v_permlane16_swap_b32 v48, v49
    s_nop 0
    v_add_f32 v48, v48, v49
    s_nop 1
    v_add_f32_dpp v48, v48, v48 row_ror:8 row_mask:0xf bank_mask:0xf
    ds_write_b32 v55, v48 offset:5120
    s_waitcnt lgkmcnt(0)
    s_barrier
    s_cmp_lg_u32 s44, 0
    s_cbranch_scc1 L_fin
    s_mov_b64 exec, 0xffff
    ds_read_b64 v[64:65], v8 offset:5120
    ds_read_b64 v[66:67], v8 offset:5248
    ds_read_b64 v[68:69], v8 offset:5376
    ds_read_b64 v[70:71], v8 offset:5504
    ds_read_b64 v[72:73], v8 offset:5632
    ds_read_b64 v[74:75], v8 offset:5760
    ds_read_b64 v[76:77], v8 offset:5888
    ds_read_b64 v[78:79], v8 offset:6016
    v_lshlrev_b32 v54, 2, v0
    s_lshl_b32 s48, s84, 10
    s_lshl_b32 s49, s85, 6
    s_add_u32 s48, s48, s49
    s_mov_b32 s60, s14
    s_mov_b32 s61, s15
    s_mov_b32 s62, 4096
    s_mov_b32 s63, 0x20000
    s_waitcnt lgkmcnt(0)
    v_add_f32 v64, v64, v72
    v_add_f32 v65, v65, v73
    v_add_f32 v66, v66, v74
    v_add_f32 v67, v67, v75
    v_add_f32 v68, v68, v76
    v_add_f32 v69, v69, v77
    v_add_f32 v70, v70, v78
    v_add_f32 v71, v71, v79
    v_add_f32 v64, v64, v68
    v_add_f32 v65, v65, v69
    v_add_f32 v66, v66, v70
    v_add_f32 v67, v67, v71
    v_add_f32 v64, v64, v66
    v_add_f32 v65, v65, v67
    v_cvt_pk_bf16_f32 v64, v64, v65
    buffer_store_dword v64, v54, s[60:63], s48 offen
    s_nop 0
L_fin:
L_end:
    s_endpgm
.section .rodata,"a"
.p2align 6
.amdhsa_kernel standalone__mha_block_cached__decode_kernel
  .amdhsa_next_free_vgpr 216
  .amdhsa_next_free_sgpr 96
  .amdhsa_accum_offset 216
  .amdhsa_group_segment_fixed_size 0
  .amdhsa_kernarg_size 64
  .amdhsa_user_sgpr_count 2
  .amdhsa_user_sgpr_kernarg_segment_ptr 1
  .amdhsa_system_sgpr_workgroup_id_x 1
.end_amdhsa_kernel
```
